```python
import torch

def _softmax(x, axis=-1):
    return torch.softmax(x, dim=axis)
def _gelu(x):
    return torch.nn.functional.gelu(x, approximate="tanh")
def _silu(x):
    return torch.nn.functional.silu(x)
def _sigmoid(x):
    return torch.sigmoid(x)
def _layernorm(x, axis=-1, eps=1e-5):
    m = x.mean(dim=axis, keepdim=True)
    v = x.var(dim=axis, keepdim=True, unbiased=False)
    return (x - m) / torch.sqrt(v + eps)
def _scatter_add(tgt, idx, src, axis=0):
    return tgt.clone().index_add_(axis, idx, src)
def _segment_sum(src, seg, n):
    out = torch.zeros((n,) + src.shape[1:], dtype=src.dtype)
    return out.index_add_(0, seg, src)
def _pad(x, pw):
    flat = tuple(v for pair in reversed(pw) for v in pair)
    return torch.nn.functional.pad(x, flat)

kernel_name = 'sequential_preLN__mha_block__dense_activation_squared_relu__prompt'

def setup_inputs():

    _w = (lambda a: (lambda t: t.to(torch.bfloat16) if t.is_floating_point() else t)(torch.as_tensor(a)))
    def _A_setup():
        B, S, D, H = 1, 2048, 512, 32
        return {
            "x": _w((lambda *s: torch.randn(*s, dtype=torch.bfloat16) * 0.05)(B, S, D)),
            "wqkv": _w((lambda *s: torch.randn(*s, dtype=torch.bfloat16) * 0.05)(D, 3 * D)),
            "wo": _w((lambda *s: torch.randn(*s, dtype=torch.bfloat16) * 0.05)(D, D)),
        }
    _A_in = _A_setup()

    def _B_setup():
        B, S, D, F = 1, 2048, 512, 1376
        return {
            "x": _w((lambda *s: torch.randn(*s, dtype=torch.bfloat16) * 0.05)(B, S, D)),
            "w1": _w((lambda *s: torch.randn(*s, dtype=torch.bfloat16) * 0.05)(D, F)),
            "b1": _w((lambda *s: torch.randn(*s, dtype=torch.bfloat16) * 0.4)(F)),
            "w2": _w((lambda *s: torch.randn(*s, dtype=torch.bfloat16) * 0.05)(F, D)),
            "b2": _w((lambda *s: torch.randn(*s, dtype=torch.bfloat16) * 1.6)(D)),
        }
    _B_in = _B_setup()

    return {
        "A_x": _A_in["x"],
        "A_wqkv": _A_in["wqkv"],
        "A_wo": _A_in["wo"],
        "B_x": _B_in["x"],
        "B_w1": _B_in["w1"],
        "B_b1": _B_in["b1"],
        "B_w2": _B_in["w2"],
        "B_b2": _B_in["b2"],
    }

def reference(A_x, A_wqkv, A_wo, B_x, B_w1, B_b1, B_w2, B_b2):
    def _A_ref(x, wqkv, wo):
        B, S, D = x.shape
        H = 32
        Dh = D // H
        qkv = (lambda x, *d: x.permute(*d))((x @ wqkv).reshape(B, S, 3, H, Dh), 2, 0, 3, 1, 4)
        q, k, v = qkv[0], qkv[1], qkv[2]
        scores = torch.einsum("bhqd,bhkd->bhqk", q, k) * (Dh ** -0.5)
        p = _softmax(scores, axis=-1)
        o = torch.einsum("bhqk,bhkd->bhqd", p, v)
        return (lambda x, *d: x.permute(*d))(o, 0, 2, 1, 3).reshape(B, S, D) @ wo

    def _B_ref(x, w1, b1, w2, b2):
        h = torch.einsum("bsd,df->bsf", x, w1) + b1
        zero = torch.zeros_like(h)
        r = torch.where(h > zero, h, zero)
        h = r * r
        out = torch.einsum("bsf,fd->bsd", h, w2) + b2
        return out

    x = A_x
    h = x + _A_ref(_layernorm(x, axis=-1), A_wqkv, A_wo)
    h2 = h + _B_ref(_layernorm(h, axis=-1), B_w1, B_b1, B_w2, B_b2)
    return h2
```

```asm
; @launch kernel=sequential_preLN__mha_block__dense_activation_squared_relu__prompt_kernel grid=(256,1,1) block=(512,1,1) lds=163840
.amdgcn_target "amdgcn-amd-amdhsa--gfx950"
.text
.globl sequential_preLN__mha_block__dense_activation_squared_relu__prompt_kernel
.p2align 8
.type sequential_preLN__mha_block__dense_activation_squared_relu__prompt_kernel,@function
sequential_preLN__mha_block__dense_activation_squared_relu__prompt_kernel:
    s_cmp_ge_u32 s2, 256
    s_cbranch_scc1 L_end
    s_load_dwordx16 s[52:67], s[0:1], 0
    s_load_dwordx4 s[68:71], s[0:1], 64
    s_load_dwordx2 s[72:73], s[0:1], 80
    v_and_b32 v253, 63, v0
    v_lshrrev_b32 v2, 6, v0
    v_lshlrev_b32 v252, 4, v253
    v_readfirstlane_b32 s44, v2
    s_and_b32 s42, s2, 7
    s_lshr_b32 s43, s2, 3
    s_mov_b32 s48, 0x0000ffff
    s_mov_b32 s49, 0x0000ffff
    s_getreg_b32 s75, hwreg(HW_REG_XCC_ID, 0, 4)
    s_mov_b32 s47, 0
    s_lshr_b32 s100, s43, 2
    s_and_b32 s101, s43, 3
    s_and_b32 s3, s44, 3
    s_lshr_b32 s51, s44, 2
    v_lshrrev_b32 v10, 3, v253
    v_and_b32 v11, 7, v253
    v_lshrrev_b32 v12, 4, v253
    s_and_b32 s85, s44, 1
    s_lshl_b32 s85, s85, 2
    v_add_u32 v13, s85, v12
    v_xor_b32 v13, v11, v13
    v_lshlrev_b32 v13, 4, v13
    v_lshl_add_u32 v2, v10, 10, v13
    v_mul_u32_u24 v10, 3072, v10
    v_and_b32 v12, 1, v12
    v_lshrrev_b32 v13, 1, v11
    v_and_b32 v14, 1, v11
    v_lshl_add_u32 v10, v14, 4, v10
    v_xor_b32 v14, v13, v12
    v_lshl_add_u32 v3, v14, 5, v10
    v_xor_b32 v14, 2, v14
    v_lshl_add_u32 v4, v14, 5, v10
    v_add_u32 v4, 1024, v4
    v_lshlrev_b32 v12, 1, v12
    v_xor_b32 v14, v13, v12
    v_lshl_add_u32 v5, v14, 5, v10
    v_add_u32 v5, 2048, v5
    s_lshl_b32 s80, s42, 8
    s_lshl_b32 s85, s101, 6
    s_add_u32 s80, s80, s85
    s_lshl_b32 s85, s44, 3
    s_add_u32 s80, s80, s85
    s_lshl_b32 s80, s80, 10
    s_mul_i32 s77, s85, 3072
    s_lshl_b32 s85, s100, 7
    s_add_u32 s77, s77, s85
    s_lshl_b32 s78, s44, 10
    s_waitcnt lgkmcnt(0)
    s_mov_b32 s4, s52
    s_mov_b32 s5, s53
    s_mov_b32 s6, 2097152
    s_mov_b32 s7, 0x00020000
    s_mov_b32 s8, s54
    s_mov_b32 s9, s55
    s_mov_b32 s10, 1572864
    s_mov_b32 s11, 0x00020000
    s_mov_b32 s12, s72
    s_mov_b32 s13, s73
    s_mov_b32 s14, 25165824
    s_mov_b32 s15, 0x00020000
    s_mov_b32 s88, s42
    v_mov_b32 v30, 0
    buffer_load_dword v31, v30, s[12:15], 0 offen
    s_add_u32 s86, s88, 0
    s_and_b32 s86, s86, 7
    s_lshl_b32 s85, s86, 7
    s_add_u32 s85, s85, s80
    s_add_u32 m0, s78, 0
    s_mul_i32 s86, s86, 196608
    buffer_load_dwordx4 v2, s[4:7], s85 offen lds
    s_add_u32 m0, s78, 8192
    s_add_u32 s85, s77, s86
    buffer_load_dwordx4 v3, s[8:11], s85 offen lds
    s_add_u32 m0, s78, 16384
    s_nop 0
    buffer_load_dwordx4 v4, s[8:11], s85 offen lds
    s_add_u32 m0, s78, 24576
    s_nop 0
    buffer_load_dwordx4 v5, s[8:11], s85 offen lds
    s_barrier
    s_add_u32 s86, s88, 1
    s_and_b32 s86, s86, 7
    s_lshl_b32 s85, s86, 7
    s_add_u32 s85, s85, s80
    s_add_u32 m0, s78, 32768
    s_mul_i32 s86, s86, 196608
    buffer_load_dwordx4 v2, s[4:7], s85 offen lds
    s_add_u32 m0, s78, 40960
    s_add_u32 s85, s77, s86
    buffer_load_dwordx4 v3, s[8:11], s85 offen lds
    s_add_u32 m0, s78, 49152
    s_nop 0
    buffer_load_dwordx4 v4, s[8:11], s85 offen lds
    s_add_u32 m0, s78, 57344
    s_nop 0
    buffer_load_dwordx4 v5, s[8:11], s85 offen lds
    v_and_b32 v20, 31, v253
    v_lshrrev_b32 v21, 5, v253
    v_bfe_u32 v22, v253, 1, 3
    v_xor_b32 v22, v21, v22
    v_lshlrev_b32 v22, 4, v22
    v_lshl_add_u32 v22, v20, 7, v22
    s_lshl_b32 s85, s51, 12
    v_add_u32 v8, s85, v22
    v_xor_b32 v9, 32, v8
    v_xor_b32 v10, 64, v8
    v_xor_b32 v11, 96, v8
    s_lshl_b32 s85, s3, 5
    v_xor_b32 v7, s85, v8
    v_bfe_u32 v20, v253, 2, 2
    v_lshl_add_u32 v23, v21, 3, v20
    v_lshlrev_b32 v23, 7, v23
    v_and_b32 v22, 3, v253
    v_lshl_add_u32 v23, v22, 3, v23
    v_bfe_u32 v24, v253, 3, 1
    v_bfe_u32 v25, v253, 4, 1
    v_lshlrev_b32 v26, 1, v25
    v_xor_b32 v26, v26, v24
    v_xor_b32 v26, s3, v26
    v_lshl_add_u32 v12, v26, 5, v23
    v_lshl_add_u32 v12, v25, 13, v12
    v_add_u32 v12, 8192, v12
    s_and_b32 s85, s3, 2
    v_lshlrev_b32 v26, 1, v24
    v_or_b32 v25, s85, v25
    v_xor_b32 v26, v26, v25
    v_lshl_add_u32 v13, v26, 5, v23
    v_add_u32 v13, 24576, v13
    v_mov_b32 v18, 0x3f803f80
    v_mov_b32 v14, 0
    v_mov_b32 v15, 0
    v_mov_b32 v16, 0
    v_mov_b32 v17, 0
    v_mov_b32 v22, 0
    v_mov_b32 v23, 0
    v_mov_b32 v48, 0
    v_mov_b32 v49, 0
    v_mov_b32 v50, 0
    v_mov_b32 v51, 0
    v_mov_b32 v52, 0
    v_mov_b32 v53, 0
    v_mov_b32 v54, 0
    v_mov_b32 v55, 0
    v_mov_b32 v56, 0
    v_mov_b32 v57, 0
    v_mov_b32 v58, 0
    v_mov_b32 v59, 0
    v_mov_b32 v60, 0
    v_mov_b32 v61, 0
    v_mov_b32 v62, 0
    v_mov_b32 v63, 0
    v_mov_b32 v64, 0
    v_mov_b32 v65, 0
    v_mov_b32 v66, 0
    v_mov_b32 v67, 0
    v_mov_b32 v68, 0
    v_mov_b32 v69, 0
    v_mov_b32 v70, 0
    v_mov_b32 v71, 0
    v_mov_b32 v72, 0
    v_mov_b32 v73, 0
    v_mov_b32 v74, 0
    v_mov_b32 v75, 0
    v_mov_b32 v76, 0
    v_mov_b32 v77, 0
    v_mov_b32 v78, 0
    v_mov_b32 v79, 0
    s_cmp_ge_u32 s44, 3
    s_cbranch_scc1 L_p1_nopt
    s_lshl_b32 s85, s43, 3
    s_add_u32 s85, s85, s42
    s_lshl_b32 s86, s85, 14
    s_lshl_b32 s85, s85, 13
    s_add_u32 s85, s85, 16777216
    s_cmp_eq_u32 s44, 0
    s_cbranch_scc1 L_p1_ptgo
    s_sub_u32 s85, s44, 1
    s_and_b32 s89, s85, 1
    s_lshl_b32 s89, s89, 13
    s_add_u32 s86, s86, s89
    s_cmp_lt_u32 s85, 2
    s_mov_b32 s85, 1048576
    s_cselect_b32 s85, 18874368, s85
    s_add_u32 s85, s85, s86
L_p1_ptgo:
    v_lshlrev_b32 v44, 7, v253
    buffer_load_dword v45, v44, s[12:15], s85 offen
L_p1_nopt:
    s_lshl_b32 s92, s100, 2
    s_add_u32 s92, s92, s3
    s_lshl_b32 s92, s92, 3
    s_add_u32 s92, s92, s42
    s_lshl_b32 s93, s101, 1
    s_add_u32 s93, s93, s51
    s_lshl_b32 s93, s93, 10
    s_lshl_b32 s94, s92, 14
    s_add_u32 s94, s94, s93
    s_lshl_b32 s92, s92, 13
    s_add_u32 s92, s92, s93
    s_add_u32 s92, s92, 16777216
    s_add_u32 s93, s94, 18874368
    s_add_u32 s94, s94, 1048576
    v_bfe_u32 v144, v253, 4, 1
    s_and_b32 s86, s3, 1
    v_subrev_u32 v144, s86, v144
    v_lshlrev_b32 v144, 17, v144
    v_and_b32 v145, 15, v253
    v_lshlrev_b32 v145, 4, v145
    v_lshrrev_b32 v146, 5, v253
    v_lshl_add_u32 v145, v146, 8, v145
    v_add_u32 v144, v144, v145
    v_add_u32 v144, 139264, v144
    s_mov_b32 s16, s56
    s_mov_b32 s17, s57
    s_mov_b32 s18, 524288
    s_mov_b32 s19, 0x00020000
    s_mov_b32 s20, s60
    s_mov_b32 s21, s61
    s_mov_b32 s22, 1409024
    s_mov_b32 s23, 0x00020000
    s_mov_b32 s32, s62
    s_mov_b32 s33, s63
    s_mov_b32 s34, 2752
    s_mov_b32 s35, 0x00020000
    s_mov_b32 s24, s64
    s_mov_b32 s25, s65
    s_mov_b32 s26, 1409024
    s_mov_b32 s27, 0x00020000
    s_mov_b32 s36, s66
    s_mov_b32 s37, s67
    s_mov_b32 s38, 1024
    s_mov_b32 s39, 0x00020000
    s_mov_b32 s28, s68
    s_mov_b32 s29, s69
    s_mov_b32 s30, 2097152
    s_mov_b32 s31, 0x00020000
    s_mov_b32 s40, s70
    s_mov_b32 s41, s71
    s_waitcnt vmcnt(4)
    v_readfirstlane_b32 s45, v31
    s_waitcnt lgkmcnt(0)
    s_mul_i32 s45, s45, 1664525
    s_add_u32 s45, s45, 1013904223
    s_barrier
    s_and_b32 s85, s3, 1
    s_lshl_b32 s85, s85, 12
    v_add_u32 v6, s85, v13
    v_add_u32 v148, 0x10000, v8
    v_add_u32 v149, 0x10000, v9
    v_add_u32 v150, 0x10000, v10
    v_add_u32 v151, 0x10000, v11
    v_add_u32 v152, 0x10000, v12
    v_add_u32 v153, 0x10000, v13
    v_add_u32 v154, 0x10000, v7
    v_add_u32 v155, 0x10000, v6
    v_mov_b32 v156, 0x3f803f80
    v_mov_b32 v157, 0x3f803f80
    v_mov_b32 v158, 0x3f803f80
    v_mov_b32 v159, 0x3f803f80
    v_mov_b32 v160, 0
    v_mov_b32 v161, 0
    v_mov_b32 v162, 0
    v_mov_b32 v163, 0
    v_mov_b32 v164, 0
    v_mov_b32 v165, 0
    v_mov_b32 v166, 0
    v_mov_b32 v167, 0
    v_mov_b32 v168, 0
    v_mov_b32 v169, 0
    v_mov_b32 v170, 0
    v_mov_b32 v171, 0
    v_mov_b32 v172, 0
    v_mov_b32 v173, 0
    v_mov_b32 v174, 0
    v_mov_b32 v175, 0
    s_cmp_lg_u32 s44, 0
    s_cbranch_scc1 L_p1_nohello
    s_lshl_b32 s85, s42, 7
    s_lshl_b32 s86, s43, 2
    s_add_u32 s85, s85, s86
    s_add_u32 s85, s85, 65536
    s_add_u32 s86, s45, s75
    s_add_u32 s86, s86, 1
    v_mov_b32 v28, s86
    v_mov_b32 v29, 0
    s_mov_b64 exec, 1
    buffer_store_dword v28, v29, s[12:15], s85 offen sc1
    s_mov_b64 exec, -1
L_p1_nohello:
    s_and_b32 s85, s3, 1
    s_cmp_eq_u32 s85, s51
    s_cbranch_scc0 L_p1_nonowner
    ds_read_b128 v[96:99], v7 offset:0
    ds_read_b128 v[80:83], v8 offset:0
    ds_read_b64_tr_b16 v[112:113], v12 offset:0
    ds_read_b64_tr_b16 v[114:115], v12 offset:512
    ds_read_b64_tr_b16 v[116:117], v13 offset:0
    ds_read_b64_tr_b16 v[118:119], v13 offset:512
    ds_read_b128 v[84:87], v9 offset:0
    ds_read_b64_tr_b16 v[120:121], v12 offset:2048
    ds_read_b64_tr_b16 v[122:123], v12 offset:2560
    ds_read_b64_tr_b16 v[124:125], v13 offset:2048
    ds_read_b64_tr_b16 v[126:127], v13 offset:2560
    s_waitcnt lgkmcnt(5)
    v_mfma_f32_32x32x16_bf16 v[48:63], v[112:115], v[80:83], v[48:63]
    s_add_u32 s86, s88, 2
    s_and_b32 s86, s86, 7
    s_lshl_b32 s85, s86, 7
    s_add_u32 s85, s85, s80
    s_add_u32 m0, s78, 65536
    s_mul_i32 s86, s86, 196608
    buffer_load_dwordx4 v2, s[4:7], s85 offen lds
    s_add_u32 m0, s78, 73728
    s_add_u32 s85, s77, s86
    buffer_load_dwordx4 v3, s[8:11], s85 offen lds
    s_add_u32 m0, s78, 81920
    s_nop 0
    buffer_load_dwordx4 v4, s[8:11], s85 offen lds
    s_add_u32 m0, s78, 90112
    s_nop 0
    buffer_load_dwordx4 v5, s[8:11], s85 offen lds
    ds_read_b128 v[88:91], v10 offset:0
    ds_read_b64_tr_b16 v[128:129], v12 offset:4096
    ds_read_b64_tr_b16 v[130:131], v12 offset:4608
    ds_read_b64_tr_b16 v[132:133], v13 offset:4096
    ds_read_b64_tr_b16 v[134:135], v13 offset:4608
    v_mfma_f32_32x32x16_bf16 v[64:79], v[80:83], v[116:119], v[64:79]
    v_lshlrev_b32 v36, 16, v96
    v_and_b32 v37, 0xffff0000, v96
    v_fmac_f32 v14, v36, v36
    v_add_f32 v22, v22, v36
    v_fmac_f32 v15, v37, v37
    v_add_f32 v23, v23, v37
    s_waitcnt lgkmcnt(5)
    v_mfma_f32_32x32x16_bf16 v[48:63], v[120:123], v[84:87], v[48:63]
    s_add_u32 s86, s88, 3
    s_and_b32 s86, s86, 7
    s_lshl_b32 s85, s86, 7
    s_add_u32 s85, s85, s80
    s_add_u32 m0, s78, 98304
    s_mul_i32 s86, s86, 196608
    buffer_load_dwordx4 v2, s[4:7], s85 offen lds
    s_add_u32 m0, s78, 106496
    s_add_u32 s85, s77, s86
    buffer_load_dwordx4 v3, s[8:11], s85 offen lds
    s_add_u32 m0, s78, 114688
    s_nop 0
    buffer_load_dwordx4 v4, s[8:11], s85 offen lds
    s_add_u32 m0, s78, 122880
    s_nop 0
    buffer_load_dwordx4 v5, s[8:11], s85 offen lds
    ds_read_b128 v[92:95], v11 offset:0
    ds_read_b64_tr_b16 v[136:137], v12 offset:6144
    ds_read_b64_tr_b16 v[138:139], v12 offset:6656
    ds_read_b64_tr_b16 v[140:141], v13 offset:6144
    ds_read_b64_tr_b16 v[142:143], v13 offset:6656
    v_mfma_f32_32x32x16_bf16 v[64:79], v[84:87], v[124:127], v[64:79]
    v_lshlrev_b32 v38, 16, v97
    v_and_b32 v39, 0xffff0000, v97
    v_fmac_f32 v14, v38, v38
    v_add_f32 v22, v22, v38
    v_fmac_f32 v15, v39, v39
    v_add_f32 v23, v23, v39
    s_waitcnt vmcnt(8) lgkmcnt(5)
    s_barrier
    v_mfma_f32_32x32x16_bf16 v[48:63], v[128:131], v[88:91], v[48:63]
    ds_read_b128 v[100:103], v7 offset:32768
    ds_read_b128 v[80:83], v8 offset:32768
    ds_read_b64_tr_b16 v[112:113], v12 offset:32768
    ds_read_b64_tr_b16 v[114:115], v12 offset:33280
    ds_read_b64_tr_b16 v[116:117], v13 offset:32768
    ds_read_b64_tr_b16 v[118:119], v13 offset:33280
    v_mfma_f32_32x32x16_bf16 v[64:79], v[88:91], v[132:135], v[64:79]
    v_lshlrev_b32 v36, 16, v98
    v_and_b32 v37, 0xffff0000, v98
    v_fmac_f32 v14, v36, v36
    v_add_f32 v22, v22, v36
    v_fmac_f32 v15, v37, v37
    v_add_f32 v23, v23, v37
    s_waitcnt lgkmcnt(6)
    v_mfma_f32_32x32x16_bf16 v[48:63], v[136:139], v[92:95], v[48:63]
    ds_read_b128 v[84:87], v9 offset:32768
    ds_read_b64_tr_b16 v[120:121], v12 offset:34816
    ds_read_b64_tr_b16 v[122:123], v12 offset:35328
    ds_read_b64_tr_b16 v[124:125], v13 offset:34816
    ds_read_b64_tr_b16 v[126:127], v13 offset:35328
    v_lshlrev_b32 v38, 16, v99
    v_mfma_f32_32x32x16_bf16 v[64:79], v[92:95], v[140:143], v[64:79]
    v_and_b32 v39, 0xffff0000, v99
    v_fmac_f32 v14, v38, v38
    v_add_f32 v22, v22, v38
    v_fmac_f32 v15, v39, v39
    v_add_f32 v23, v23, v39
    s_waitcnt lgkmcnt(5)
    v_mfma_f32_32x32x16_bf16 v[48:63], v[112:115], v[80:83], v[48:63]
    ds_read_b128 v[88:91], v10 offset:32768
    ds_read_b64_tr_b16 v[128:129], v12 offset:36864
    ds_read_b64_tr_b16 v[130:131], v12 offset:37376
    ds_read_b64_tr_b16 v[132:133], v13 offset:36864
    ds_read_b64_tr_b16 v[134:135], v13 offset:37376
    v_lshlrev_b32 v36, 16, v100
    v_mfma_f32_32x32x16_bf16 v[64:79], v[80:83], v[116:119], v[64:79]
    v_and_b32 v37, 0xffff0000, v100
    v_fmac_f32 v14, v36, v36
    v_add_f32 v22, v22, v36
    v_fmac_f32 v15, v37, v37
    v_add_f32 v23, v23, v37
    s_waitcnt lgkmcnt(5)
    v_mfma_f32_32x32x16_bf16 v[48:63], v[120:123], v[84:87], v[48:63]
    ds_read_b128 v[92:95], v11 offset:32768
    ds_read_b64_tr_b16 v[136:137], v12 offset:38912
    ds_read_b64_tr_b16 v[138:139], v12 offset:39424
    ds_read_b64_tr_b16 v[140:141], v13 offset:38912
    ds_read_b64_tr_b16 v[142:143], v13 offset:39424
    v_lshlrev_b32 v38, 16, v101
    v_mfma_f32_32x32x16_bf16 v[64:79], v[84:87], v[124:127], v[64:79]
    v_and_b32 v39, 0xffff0000, v101
    v_fmac_f32 v14, v38, v38
    v_add_f32 v22, v22, v38
    v_fmac_f32 v15, v39, v39
    v_add_f32 v23, v23, v39
    s_waitcnt vmcnt(4) lgkmcnt(5)
    s_barrier
    v_mfma_f32_32x32x16_bf16 v[48:63], v[128:131], v[88:91], v[48:63]
    ds_read_b128 v[96:99], v154 offset:0
    ds_read_b128 v[80:83], v148 offset:0
    ds_read_b64_tr_b16 v[112:113], v152 offset:0
    ds_read_b64_tr_b16 v[114:115], v152 offset:512
    ds_read_b64_tr_b16 v[116:117], v153 offset:0
    ds_read_b64_tr_b16 v[118:119], v153 offset:512
    v_mfma_f32_32x32x16_bf16 v[64:79], v[88:91], v[132:135], v[64:79]
    v_lshlrev_b32 v36, 16, v102
    v_and_b32 v37, 0xffff0000, v102
    v_fmac_f32 v14, v36, v36
    v_add_f32 v22, v22, v36
    v_fmac_f32 v15, v37, v37
    v_add_f32 v23, v23, v37
    s_waitcnt lgkmcnt(6)
    v_mfma_f32_32x32x16_bf16 v[48:63], v[136:139], v[92:95], v[48:63]
    ds_read_b128 v[84:87], v149 offset:0
    ds_read_b64_tr_b16 v[120:121], v152 offset:2048
    ds_read_b64_tr_b16 v[122:123], v152 offset:2560
    ds_read_b64_tr_b16 v[124:125], v153 offset:2048
    ds_read_b64_tr_b16 v[126:127], v153 offset:2560
    s_add_u32 s86, s88, 4
    s_and_b32 s86, s86, 7
    s_lshl_b32 s85, s86, 7
    s_add_u32 s85, s85, s80
    s_add_u32 m0, s78, 0
    s_mul_i32 s86, s86, 196608
    buffer_load_dwordx4 v2, s[4:7], s85 offen lds
    s_add_u32 m0, s78, 8192
    s_add_u32 s85, s77, s86
    buffer_load_dwordx4 v3, s[8:11], s85 offen lds
    s_add_u32 m0, s78, 16384
    s_nop 0
    buffer_load_dwordx4 v4, s[8:11], s85 offen lds
    s_add_u32 m0, s78, 24576
    s_nop 0
    buffer_load_dwordx4 v5, s[8:11], s85 offen lds
    v_mfma_f32_32x32x16_bf16 v[64:79], v[92:95], v[140:143], v[64:79]
    v_lshlrev_b32 v38, 16, v103
    v_and_b32 v39, 0xffff0000, v103
    v_fmac_f32 v14, v38, v38
    v_add_f32 v22, v22, v38
    v_fmac_f32 v15, v39, v39
    v_add_f32 v23, v23, v39
    s_waitcnt lgkmcnt(5)
    v_mfma_f32_32x32x16_bf16 v[48:63], v[112:115], v[80:83], v[48:63]
    ds_read_b128 v[88:91], v150 offset:0
    ds_read_b64_tr_b16 v[128:129], v152 offset:4096
    ds_read_b64_tr_b16 v[130:131], v152 offset:4608
    ds_read_b64_tr_b16 v[132:133], v153 offset:4096
    ds_read_b64_tr_b16 v[134:135], v153 offset:4608
    v_lshlrev_b32 v36, 16, v96
    v_mfma_f32_32x32x16_bf16 v[64:79], v[80:83], v[116:119], v[64:79]
    v_and_b32 v37, 0xffff0000, v96
    v_fmac_f32 v14, v36, v36
    v_add_f32 v22, v22, v36
    v_fmac_f32 v15, v37, v37
    v_add_f32 v23, v23, v37
    s_waitcnt lgkmcnt(5)
    v_mfma_f32_32x32x16_bf16 v[48:63], v[120:123], v[84:87], v[48:63]
    ds_read_b128 v[92:95], v151 offset:0
    ds_read_b64_tr_b16 v[136:137], v152 offset:6144
    ds_read_b64_tr_b16 v[138:139], v152 offset:6656
    ds_read_b64_tr_b16 v[140:141], v153 offset:6144
    ds_read_b64_tr_b16 v[142:143], v153 offset:6656
    v_lshlrev_b32 v38, 16, v97
    v_mfma_f32_32x32x16_bf16 v[64:79], v[84:87], v[124:127], v[64:79]
    v_and_b32 v39, 0xffff0000, v97
    v_fmac_f32 v14, v38, v38
    v_add_f32 v22, v22, v38
    v_fmac_f32 v15, v39, v39
    v_add_f32 v23, v23, v39
    s_waitcnt vmcnt(4) lgkmcnt(5)
    s_barrier
    v_mfma_f32_32x32x16_bf16 v[48:63], v[128:131], v[88:91], v[48:63]
    ds_read_b128 v[100:103], v154 offset:32768
    ds_read_b128 v[80:83], v148 offset:32768
    ds_read_b64_tr_b16 v[112:113], v152 offset:32768
    ds_read_b64_tr_b16 v[114:115], v152 offset:33280
    ds_read_b64_tr_b16 v[116:117], v153 offset:32768
    ds_read_b64_tr_b16 v[118:119], v153 offset:33280
    v_mfma_f32_32x32x16_bf16 v[64:79], v[88:91], v[132:135], v[64:79]
    v_lshlrev_b32 v36, 16, v98
    v_and_b32 v37, 0xffff0000, v98
    v_fmac_f32 v14, v36, v36
    v_add_f32 v22, v22, v36
    v_fmac_f32 v15, v37, v37
    v_add_f32 v23, v23, v37
    s_waitcnt lgkmcnt(6)
    v_mfma_f32_32x32x16_bf16 v[48:63], v[136:139], v[92:95], v[48:63]
    ds_read_b128 v[84:87], v149 offset:32768
    ds_read_b64_tr_b16 v[120:121], v152 offset:34816
    ds_read_b64_tr_b16 v[122:123], v152 offset:35328
    ds_read_b64_tr_b16 v[124:125], v153 offset:34816
    ds_read_b64_tr_b16 v[126:127], v153 offset:35328
    s_add_u32 s86, s88, 5
    s_and_b32 s86, s86, 7
    s_lshl_b32 s85, s86, 7
    s_add_u32 s85, s85, s80
    s_add_u32 m0, s78, 32768
    s_mul_i32 s86, s86, 196608
    buffer_load_dwordx4 v2, s[4:7], s85 offen lds
    s_add_u32 m0, s78, 40960
    s_add_u32 s85, s77, s86
    buffer_load_dwordx4 v3, s[8:11], s85 offen lds
    s_add_u32 m0, s78, 49152
    s_nop 0
    buffer_load_dwordx4 v4, s[8:11], s85 offen lds
    s_add_u32 m0, s78, 57344
    s_nop 0
    buffer_load_dwordx4 v5, s[8:11], s85 offen lds
    v_mfma_f32_32x32x16_bf16 v[64:79], v[92:95], v[140:143], v[64:79]
    v_lshlrev_b32 v38, 16, v99
    v_and_b32 v39, 0xffff0000, v99
    v_fmac_f32 v14, v38, v38
    v_add_f32 v22, v22, v38
    v_fmac_f32 v15, v39, v39
    v_add_f32 v23, v23, v39
    s_waitcnt lgkmcnt(5)
    v_mfma_f32_32x32x16_bf16 v[48:63], v[112:115], v[80:83], v[48:63]
    ds_read_b128 v[88:91], v150 offset:32768
    ds_read_b64_tr_b16 v[128:129], v152 offset:36864
    ds_read_b64_tr_b16 v[130:131], v152 offset:37376
    ds_read_b64_tr_b16 v[132:133], v153 offset:36864
    ds_read_b64_tr_b16 v[134:135], v153 offset:37376
    v_lshlrev_b32 v36, 16, v100
    v_mfma_f32_32x32x16_bf16 v[64:79], v[80:83], v[116:119], v[64:79]
    v_and_b32 v37, 0xffff0000, v100
    v_fmac_f32 v14, v36, v36
    v_add_f32 v22, v22, v36
    v_fmac_f32 v15, v37, v37
    v_add_f32 v23, v23, v37
    s_waitcnt lgkmcnt(5)
    v_mfma_f32_32x32x16_bf16 v[48:63], v[120:123], v[84:87], v[48:63]
    ds_read_b128 v[92:95], v151 offset:32768
    ds_read_b64_tr_b16 v[136:137], v152 offset:38912
    ds_read_b64_tr_b16 v[138:139], v152 offset:39424
    ds_read_b64_tr_b16 v[140:141], v153 offset:38912
    ds_read_b64_tr_b16 v[142:143], v153 offset:39424
    v_lshlrev_b32 v38, 16, v101
    v_mfma_f32_32x32x16_bf16 v[64:79], v[84:87], v[124:127], v[64:79]
    v_and_b32 v39, 0xffff0000, v101
    v_fmac_f32 v14, v38, v38
    v_add_f32 v22, v22, v38
    v_fmac_f32 v15, v39, v39
    v_add_f32 v23, v23, v39
    s_waitcnt vmcnt(4) lgkmcnt(5)
    s_barrier
    v_mfma_f32_32x32x16_bf16 v[48:63], v[128:131], v[88:91], v[48:63]
    ds_read_b128 v[96:99], v7 offset:0
    ds_read_b128 v[80:83], v8 offset:0
    ds_read_b64_tr_b16 v[112:113], v12 offset:0
    ds_read_b64_tr_b16 v[114:115], v12 offset:512
    ds_read_b64_tr_b16 v[116:117], v13 offset:0
    ds_read_b64_tr_b16 v[118:119], v13 offset:512
    v_mfma_f32_32x32x16_bf16 v[64:79], v[88:91], v[132:135], v[64:79]
    v_lshlrev_b32 v36, 16, v102
    v_and_b32 v37, 0xffff0000, v102
    v_fmac_f32 v14, v36, v36
    v_add_f32 v22, v22, v36
    v_fmac_f32 v15, v37, v37
    v_add_f32 v23, v23, v37
    s_waitcnt lgkmcnt(6)
    v_mfma_f32_32x32x16_bf16 v[48:63], v[136:139], v[92:95], v[48:63]
    ds_read_b128 v[84:87], v9 offset:0
    ds_read_b64_tr_b16 v[120:121], v12 offset:2048
    ds_read_b64_tr_b16 v[122:123], v12 offset:2560
    ds_read_b64_tr_b16 v[124:125], v13 offset:2048
    ds_read_b64_tr_b16 v[126:127], v13 offset:2560
    s_add_u32 s86, s88, 6
    s_and_b32 s86, s86, 7
    s_lshl_b32 s85, s86, 7
    s_add_u32 s85, s85, s80
    s_add_u32 m0, s78, 65536
    s_mul_i32 s86, s86, 196608
    buffer_load_dwordx4 v2, s[4:7], s85 offen lds
    s_add_u32 m0, s78, 73728
    s_add_u32 s85, s77, s86
    buffer_load_dwordx4 v3, s[8:11], s85 offen lds
    s_add_u32 m0, s78, 81920
    s_nop 0
    buffer_load_dwordx4 v4, s[8:11], s85 offen lds
    s_add_u32 m0, s78, 90112
    s_nop 0
    buffer_load_dwordx4 v5, s[8:11], s85 offen lds
    v_mfma_f32_32x32x16_bf16 v[64:79], v[92:95], v[140:143], v[64:79]
    v_lshlrev_b32 v38, 16, v103
    v_and_b32 v39, 0xffff0000, v103
    v_fmac_f32 v14, v38, v38
    v_add_f32 v22, v22, v38
    v_fmac_f32 v15, v39, v39
    v_add_f32 v23, v23, v39
    s_waitcnt lgkmcnt(5)
    v_mfma_f32_32x32x16_bf16 v[48:63], v[112:115], v[80:83], v[48:63]
    ds_read_b128 v[88:91], v10 offset:0
    ds_read_b64_tr_b16 v[128:129], v12 offset:4096
    ds_read_b64_tr_b16 v[130:131], v12 offset:4608
    ds_read_b64_tr_b16 v[132:133], v13 offset:4096
    ds_read_b64_tr_b16 v[134:135], v13 offset:4608
    v_lshlrev_b32 v36, 16, v96
    v_mfma_f32_32x32x16_bf16 v[64:79], v[80:83], v[116:119], v[64:79]
    v_and_b32 v37, 0xffff0000, v96
    v_fmac_f32 v14, v36, v36
    v_add_f32 v22, v22, v36
    v_fmac_f32 v15, v37, v37
    v_add_f32 v23, v23, v37
    s_waitcnt lgkmcnt(5)
    v_mfma_f32_32x32x16_bf16 v[48:63], v[120:123], v[84:87], v[48:63]
    ds_read_b128 v[92:95], v11 offset:0
    ds_read_b64_tr_b16 v[136:137], v12 offset:6144
    ds_read_b64_tr_b16 v[138:139], v12 offset:6656
    ds_read_b64_tr_b16 v[140:141], v13 offset:6144
    ds_read_b64_tr_b16 v[142:143], v13 offset:6656
    v_lshlrev_b32 v38, 16, v97
    v_mfma_f32_32x32x16_bf16 v[64:79], v[84:87], v[124:127], v[64:79]
    v_and_b32 v39, 0xffff0000, v97
    v_fmac_f32 v14, v38, v38
    v_add_f32 v22, v22, v38
    v_fmac_f32 v15, v39, v39
    v_add_f32 v23, v23, v39
    s_waitcnt vmcnt(4) lgkmcnt(5)
    s_barrier
    v_mfma_f32_32x32x16_bf16 v[48:63], v[128:131], v[88:91], v[48:63]
    ds_read_b128 v[100:103], v7 offset:32768
    ds_read_b128 v[80:83], v8 offset:32768
    ds_read_b64_tr_b16 v[112:113], v12 offset:32768
    ds_read_b64_tr_b16 v[114:115], v12 offset:33280
    ds_read_b64_tr_b16 v[116:117], v13 offset:32768
    ds_read_b64_tr_b16 v[118:119], v13 offset:33280
    v_mfma_f32_32x32x16_bf16 v[64:79], v[88:91], v[132:135], v[64:79]
    v_lshlrev_b32 v36, 16, v98
    v_and_b32 v37, 0xffff0000, v98
    v_fmac_f32 v14, v36, v36
    v_add_f32 v22, v22, v36
    v_fmac_f32 v15, v37, v37
    v_add_f32 v23, v23, v37
    s_waitcnt lgkmcnt(6)
    v_mfma_f32_32x32x16_bf16 v[48:63], v[136:139], v[92:95], v[48:63]
    ds_read_b128 v[84:87], v9 offset:32768
    ds_read_b64_tr_b16 v[120:121], v12 offset:34816
    ds_read_b64_tr_b16 v[122:123], v12 offset:35328
    ds_read_b64_tr_b16 v[124:125], v13 offset:34816
    ds_read_b64_tr_b16 v[126:127], v13 offset:35328
    s_add_u32 s86, s88, 7
    s_and_b32 s86, s86, 7
    s_lshl_b32 s85, s86, 7
    s_add_u32 s85, s85, s80
    s_add_u32 m0, s78, 98304
    s_mul_i32 s86, s86, 196608
    buffer_load_dwordx4 v2, s[4:7], s85 offen lds
    s_add_u32 m0, s78, 106496
    s_add_u32 s85, s77, s86
    buffer_load_dwordx4 v3, s[8:11], s85 offen lds
    s_add_u32 m0, s78, 114688
    s_nop 0
    buffer_load_dwordx4 v4, s[8:11], s85 offen lds
    s_add_u32 m0, s78, 122880
    s_nop 0
    buffer_load_dwordx4 v5, s[8:11], s85 offen lds
    s_lshl_b32 s85, s42, 7
    s_add_u32 s85, s85, 65536
    v_and_b32 v28, 31, v253
    v_lshlrev_b32 v28, 2, v28
    buffer_load_dword v29, v28, s[12:15], s85 offen sc1
    v_mfma_f32_32x32x16_bf16 v[64:79], v[92:95], v[140:143], v[64:79]
    v_lshlrev_b32 v38, 16, v99
    v_and_b32 v39, 0xffff0000, v99
    v_fmac_f32 v14, v38, v38
    v_add_f32 v22, v22, v38
    v_fmac_f32 v15, v39, v39
    v_add_f32 v23, v23, v39
    s_waitcnt lgkmcnt(5)
    v_mfma_f32_32x32x16_bf16 v[48:63], v[112:115], v[80:83], v[48:63]
    ds_read_b128 v[88:91], v10 offset:32768
    ds_read_b64_tr_b16 v[128:129], v12 offset:36864
    ds_read_b64_tr_b16 v[130:131], v12 offset:37376
    ds_read_b64_tr_b16 v[132:133], v13 offset:36864
    ds_read_b64_tr_b16 v[134:135], v13 offset:37376
    v_lshlrev_b32 v36, 16, v100
    v_mfma_f32_32x32x16_bf16 v[64:79], v[80:83], v[116:119], v[64:79]
    v_and_b32 v37, 0xffff0000, v100
    v_fmac_f32 v14, v36, v36
    v_add_f32 v22, v22, v36
    v_fmac_f32 v15, v37, v37
    v_add_f32 v23, v23, v37
    s_waitcnt lgkmcnt(5)
    v_mfma_f32_32x32x16_bf16 v[48:63], v[120:123], v[84:87], v[48:63]
    ds_read_b128 v[92:95], v11 offset:32768
    ds_read_b64_tr_b16 v[136:137], v12 offset:38912
    ds_read_b64_tr_b16 v[138:139], v12 offset:39424
    ds_read_b64_tr_b16 v[140:141], v13 offset:38912
    ds_read_b64_tr_b16 v[142:143], v13 offset:39424
    v_lshlrev_b32 v38, 16, v101
    v_mfma_f32_32x32x16_bf16 v[64:79], v[84:87], v[124:127], v[64:79]
    v_and_b32 v39, 0xffff0000, v101
    v_fmac_f32 v14, v38, v38
    v_add_f32 v22, v22, v38
    v_fmac_f32 v15, v39, v39
    v_add_f32 v23, v23, v39
    s_waitcnt vmcnt(5) lgkmcnt(5)
    s_barrier
    v_mfma_f32_32x32x16_bf16 v[48:63], v[128:131], v[88:91], v[48:63]
    ds_read_b128 v[96:99], v154 offset:0
    ds_read_b128 v[80:83], v148 offset:0
    ds_read_b64_tr_b16 v[112:113], v152 offset:0
    ds_read_b64_tr_b16 v[114:115], v152 offset:512
    ds_read_b64_tr_b16 v[116:117], v153 offset:0
    ds_read_b64_tr_b16 v[118:119], v153 offset:512
    v_mfma_f32_32x32x16_bf16 v[64:79], v[88:91], v[132:135], v[64:79]
    v_lshlrev_b32 v36, 16, v102
    v_and_b32 v37, 0xffff0000, v102
    v_fmac_f32 v14, v36, v36
    v_add_f32 v22, v22, v36
    v_fmac_f32 v15, v37, v37
    v_add_f32 v23, v23, v37
    s_waitcnt lgkmcnt(6)
    v_mfma_f32_32x32x16_bf16 v[48:63], v[136:139], v[92:95], v[48:63]
    ds_read_b128 v[84:87], v149 offset:0
    ds_read_b64_tr_b16 v[120:121], v152 offset:2048
    ds_read_b64_tr_b16 v[122:123], v152 offset:2560
    ds_read_b64_tr_b16 v[124:125], v153 offset:2048
    ds_read_b64_tr_b16 v[126:127], v153 offset:2560
    v_lshlrev_b32 v38, 16, v103
    v_mfma_f32_32x32x16_bf16 v[64:79], v[92:95], v[140:143], v[64:79]
    v_and_b32 v39, 0xffff0000, v103
    v_fmac_f32 v14, v38, v38
    v_add_f32 v22, v22, v38
    v_fmac_f32 v15, v39, v39
    v_add_f32 v23, v23, v39
    s_waitcnt lgkmcnt(5)
    v_mfma_f32_32x32x16_bf16 v[48:63], v[112:115], v[80:83], v[48:63]
    ds_read_b128 v[88:91], v150 offset:0
    ds_read_b64_tr_b16 v[128:129], v152 offset:4096
    ds_read_b64_tr_b16 v[130:131], v152 offset:4608
    ds_read_b64_tr_b16 v[132:133], v153 offset:4096
    ds_read_b64_tr_b16 v[134:135], v153 offset:4608
    v_lshlrev_b32 v36, 16, v96
    v_mfma_f32_32x32x16_bf16 v[64:79], v[80:83], v[116:119], v[64:79]
    v_and_b32 v37, 0xffff0000, v96
    v_fmac_f32 v14, v36, v36
    v_add_f32 v22, v22, v36
    v_fmac_f32 v15, v37, v37
    v_add_f32 v23, v23, v37
    s_waitcnt lgkmcnt(5)
    v_mfma_f32_32x32x16_bf16 v[48:63], v[120:123], v[84:87], v[48:63]
    ds_read_b128 v[92:95], v151 offset:0
    ds_read_b64_tr_b16 v[136:137], v152 offset:6144
    ds_read_b64_tr_b16 v[138:139], v152 offset:6656
    ds_read_b64_tr_b16 v[140:141], v153 offset:6144
    ds_read_b64_tr_b16 v[142:143], v153 offset:6656
    v_lshlrev_b32 v38, 16, v97
    v_mfma_f32_32x32x16_bf16 v[64:79], v[84:87], v[124:127], v[64:79]
    v_and_b32 v39, 0xffff0000, v97
    v_fmac_f32 v14, v38, v38
    v_add_f32 v22, v22, v38
    v_fmac_f32 v15, v39, v39
    v_add_f32 v23, v23, v39
    s_waitcnt vmcnt(1) lgkmcnt(5)
    s_barrier
    v_mfma_f32_32x32x16_bf16 v[48:63], v[128:131], v[88:91], v[48:63]
    ds_read_b128 v[100:103], v154 offset:32768
    ds_read_b128 v[80:83], v148 offset:32768
    ds_read_b64_tr_b16 v[112:113], v152 offset:32768
    ds_read_b64_tr_b16 v[114:115], v152 offset:33280
    ds_read_b64_tr_b16 v[116:117], v153 offset:32768
    ds_read_b64_tr_b16 v[118:119], v153 offset:33280
    v_mfma_f32_32x32x16_bf16 v[64:79], v[88:91], v[132:135], v[64:79]
    v_lshlrev_b32 v36, 16, v98
    v_and_b32 v37, 0xffff0000, v98
    v_fmac_f32 v14, v36, v36
    v_add_f32 v22, v22, v36
    v_fmac_f32 v15, v37, v37
    v_add_f32 v23, v23, v37
    s_waitcnt lgkmcnt(6)
    v_mfma_f32_32x32x16_bf16 v[48:63], v[136:139], v[92:95], v[48:63]
    ds_read_b128 v[84:87], v149 offset:32768
    ds_read_b64_tr_b16 v[120:121], v152 offset:34816
    ds_read_b64_tr_b16 v[122:123], v152 offset:35328
    ds_read_b64_tr_b16 v[124:125], v153 offset:34816
    ds_read_b64_tr_b16 v[126:127], v153 offset:35328
    v_lshlrev_b32 v38, 16, v99
    v_mfma_f32_32x32x16_bf16 v[64:79], v[92:95], v[140:143], v[64:79]
    v_and_b32 v39, 0xffff0000, v99
    v_fmac_f32 v14, v38, v38
    v_add_f32 v22, v22, v38
    v_fmac_f32 v15, v39, v39
    v_add_f32 v23, v23, v39
    s_waitcnt lgkmcnt(5)
    v_mfma_f32_32x32x16_bf16 v[48:63], v[112:115], v[80:83], v[48:63]
    ds_read_b128 v[88:91], v150 offset:32768
    ds_read_b64_tr_b16 v[128:129], v152 offset:36864
    ds_read_b64_tr_b16 v[130:131], v152 offset:37376
    ds_read_b64_tr_b16 v[132:133], v153 offset:36864
    ds_read_b64_tr_b16 v[134:135], v153 offset:37376
    v_lshlrev_b32 v36, 16, v100
    v_mfma_f32_32x32x16_bf16 v[64:79], v[80:83], v[116:119], v[64:79]
    v_and_b32 v37, 0xffff0000, v100
    v_fmac_f32 v14, v36, v36
    v_add_f32 v22, v22, v36
    v_fmac_f32 v15, v37, v37
    v_add_f32 v23, v23, v37
    s_waitcnt lgkmcnt(5)
    v_mfma_f32_32x32x16_bf16 v[48:63], v[120:123], v[84:87], v[48:63]
    ds_read_b128 v[92:95], v151 offset:32768
    ds_read_b64_tr_b16 v[136:137], v152 offset:38912
    ds_read_b64_tr_b16 v[138:139], v152 offset:39424
    ds_read_b64_tr_b16 v[140:141], v153 offset:38912
    ds_read_b64_tr_b16 v[142:143], v153 offset:39424
    v_lshlrev_b32 v38, 16, v101
    v_mfma_f32_32x32x16_bf16 v[64:79], v[84:87], v[124:127], v[64:79]
    v_and_b32 v39, 0xffff0000, v101
    v_fmac_f32 v14, v38, v38
    v_add_f32 v22, v22, v38
    v_fmac_f32 v15, v39, v39
    v_add_f32 v23, v23, v39
    s_waitcnt lgkmcnt(5)
    v_mfma_f32_32x32x16_bf16 v[48:63], v[128:131], v[88:91], v[48:63]
    v_lshlrev_b32 v36, 16, v102
    v_and_b32 v37, 0xffff0000, v102
    v_fmac_f32 v14, v36, v36
    v_mfma_f32_32x32x16_bf16 v[64:79], v[88:91], v[132:135], v[64:79]
    v_add_f32 v22, v22, v36
    v_fmac_f32 v15, v37, v37
    v_add_f32 v23, v23, v37
    s_waitcnt lgkmcnt(0)
    v_mfma_f32_32x32x16_bf16 v[48:63], v[136:139], v[92:95], v[48:63]
    v_lshlrev_b32 v38, 16, v103
    v_and_b32 v39, 0xffff0000, v103
    v_fmac_f32 v14, v38, v38
    v_mfma_f32_32x32x16_bf16 v[64:79], v[92:95], v[140:143], v[64:79]
    v_add_f32 v22, v22, v38
    v_fmac_f32 v15, v39, v39
    v_add_f32 v23, v23, v39
    s_branch L_p1_joined
L_p1_nonowner:
    ds_read_b128 v[96:99], v7 offset:0
    ds_read_b64_tr_b16 v[176:177], v6 offset:0
    ds_read_b64_tr_b16 v[178:179], v6 offset:512
    ds_read_b64_tr_b16 v[180:181], v6 offset:2048
    ds_read_b64_tr_b16 v[182:183], v6 offset:2560
    ds_read_b128 v[80:83], v8 offset:0
    ds_read_b64_tr_b16 v[112:113], v12 offset:0
    ds_read_b64_tr_b16 v[114:115], v12 offset:512
    ds_read_b128 v[84:87], v9 offset:0
    ds_read_b64_tr_b16 v[120:121], v12 offset:2048
    ds_read_b64_tr_b16 v[122:123], v12 offset:2560
    s_waitcnt lgkmcnt(3)
    v_mfma_f32_32x32x16_bf16 v[48:63], v[112:115], v[80:83], v[48:63]
    s_add_u32 s86, s88, 2
    s_and_b32 s86, s86, 7
    s_lshl_b32 s85, s86, 7
    s_add_u32 s85, s85, s80
    s_add_u32 m0, s78, 65536
    s_mul_i32 s86, s86, 196608
    buffer_load_dwordx4 v2, s[4:7], s85 offen lds
    s_add_u32 m0, s78, 73728
    s_add_u32 s85, s77, s86
    buffer_load_dwordx4 v3, s[8:11], s85 offen lds
    s_add_u32 m0, s78, 81920
    s_nop 0
    buffer_load_dwordx4 v4, s[8:11], s85 offen lds
    s_add_u32 m0, s78, 90112
    s_nop 0
    buffer_load_dwordx4 v5, s[8:11], s85 offen lds
    ds_read_b128 v[88:91], v10 offset:0
    ds_read_b64_tr_b16 v[128:129], v12 offset:4096
    ds_read_b64_tr_b16 v[130:131], v12 offset:4608
    v_mfma_f32_32x32x16_bf16 v[64:79], v[112:115], v[156:159], v[64:79]
    v_lshlrev_b32 v36, 16, v96
    v_and_b32 v37, 0xffff0000, v96
    v_fmac_f32 v14, v36, v36
    v_add_f32 v22, v22, v36
    v_mfma_f32_32x32x16_bf16 v[160:175], v[156:159], v[176:179], v[160:175]
    v_fmac_f32 v15, v37, v37
    v_add_f32 v23, v23, v37
    s_waitcnt lgkmcnt(3)
    v_mfma_f32_32x32x16_bf16 v[48:63], v[120:123], v[84:87], v[48:63]
    s_add_u32 s86, s88, 3
    s_and_b32 s86, s86, 7
    s_lshl_b32 s85, s86, 7
    s_add_u32 s85, s85, s80
    s_add_u32 m0, s78, 98304
    s_mul_i32 s86, s86, 196608
    buffer_load_dwordx4 v2, s[4:7], s85 offen lds
    s_add_u32 m0, s78, 106496
    s_add_u32 s85, s77, s86
    buffer_load_dwordx4 v3, s[8:11], s85 offen lds
    s_add_u32 m0, s78, 114688
    s_nop 0
    buffer_load_dwordx4 v4, s[8:11], s85 offen lds
    s_add_u32 m0, s78, 122880
    s_nop 0
    buffer_load_dwordx4 v5, s[8:11], s85 offen lds
    ds_read_b128 v[92:95], v11 offset:0
    ds_read_b64_tr_b16 v[136:137], v12 offset:6144
    ds_read_b64_tr_b16 v[138:139], v12 offset:6656
    v_mfma_f32_32x32x16_bf16 v[64:79], v[120:123], v[156:159], v[64:79]
    v_lshlrev_b32 v38, 16, v97
    v_and_b32 v39, 0xffff0000, v97
    v_fmac_f32 v14, v38, v38
    v_add_f32 v22, v22, v38
    v_mfma_f32_32x32x16_bf16 v[160:175], v[156:159], v[180:183], v[160:175]
    v_fmac_f32 v15, v39, v39
    v_add_f32 v23, v23, v39
    s_waitcnt vmcnt(8) lgkmcnt(3)
    s_barrier
    v_mfma_f32_32x32x16_bf16 v[48:63], v[128:131], v[88:91], v[48:63]
    ds_read_b128 v[100:103], v7 offset:32768
    ds_read_b64_tr_b16 v[184:185], v6 offset:32768
    ds_read_b64_tr_b16 v[186:187], v6 offset:33280
    ds_read_b64_tr_b16 v[188:189], v6 offset:34816
    ds_read_b64_tr_b16 v[190:191], v6 offset:35328
    ds_read_b128 v[80:83], v8 offset:32768
    ds_read_b64_tr_b16 v[112:113], v12 offset:32768
    v_mfma_f32_32x32x16_bf16 v[64:79], v[128:131], v[156:159], v[64:79]
    ds_read_b64_tr_b16 v[114:115], v12 offset:33280
    v_lshlrev_b32 v36, 16, v98
    v_and_b32 v37, 0xffff0000, v98
    v_fmac_f32 v14, v36, v36
    v_add_f32 v22, v22, v36
    v_fmac_f32 v15, v37, v37
    v_add_f32 v23, v23, v37
    s_waitcnt lgkmcnt(8)
    v_mfma_f32_32x32x16_bf16 v[48:63], v[136:139], v[92:95], v[48:63]
    ds_read_b128 v[84:87], v9 offset:32768
    ds_read_b64_tr_b16 v[120:121], v12 offset:34816
    ds_read_b64_tr_b16 v[122:123], v12 offset:35328
    v_lshlrev_b32 v38, 16, v99
    v_and_b32 v39, 0xffff0000, v99
    v_mfma_f32_32x32x16_bf16 v[64:79], v[136:139], v[156:159], v[64:79]
    v_fmac_f32 v14, v38, v38
    v_add_f32 v22, v22, v38
    v_fmac_f32 v15, v39, v39
    v_add_f32 v23, v23, v39
    s_waitcnt lgkmcnt(3)
    v_mfma_f32_32x32x16_bf16 v[48:63], v[112:115], v[80:83], v[48:63]
    ds_read_b128 v[88:91], v10 offset:32768
    ds_read_b64_tr_b16 v[128:129], v12 offset:36864
    ds_read_b64_tr_b16 v[130:131], v12 offset:37376
    v_mfma_f32_32x32x16_bf16 v[64:79], v[112:115], v[156:159], v[64:79]
    v_lshlrev_b32 v36, 16, v100
    v_and_b32 v37, 0xffff0000, v100
    v_fmac_f32 v14, v36, v36
    v_mfma_f32_32x32x16_bf16 v[160:175], v[156:159], v[184:187], v[160:175]
    v_add_f32 v22, v22, v36
    v_fmac_f32 v15, v37, v37
    v_add_f32 v23, v23, v37
    s_waitcnt lgkmcnt(3)
    v_mfma_f32_32x32x16_bf16 v[48:63], v[120:123], v[84:87], v[48:63]
    ds_read_b128 v[92:95], v11 offset:32768
    ds_read_b64_tr_b16 v[136:137], v12 offset:38912
    ds_read_b64_tr_b16 v[138:139], v12 offset:39424
    v_mfma_f32_32x32x16_bf16 v[64:79], v[120:123], v[156:159], v[64:79]
    v_lshlrev_b32 v38, 16, v101
    v_and_b32 v39, 0xffff0000, v101
    v_fmac_f32 v14, v38, v38
    v_mfma_f32_32x32x16_bf16 v[160:175], v[156:159], v[188:191], v[160:175]
    v_add_f32 v22, v22, v38
    v_fmac_f32 v15, v39, v39
    v_add_f32 v23, v23, v39
    s_waitcnt vmcnt(4) lgkmcnt(3)
    s_barrier
    v_mfma_f32_32x32x16_bf16 v[48:63], v[128:131], v[88:91], v[48:63]
    ds_read_b128 v[96:99], v154 offset:0
    ds_read_b64_tr_b16 v[176:177], v155 offset:0
    ds_read_b64_tr_b16 v[178:179], v155 offset:512
    ds_read_b64_tr_b16 v[180:181], v155 offset:2048
    ds_read_b64_tr_b16 v[182:183], v155 offset:2560
    ds_read_b128 v[80:83], v148 offset:0
    ds_read_b64_tr_b16 v[112:113], v152 offset:0
    v_mfma_f32_32x32x16_bf16 v[64:79], v[128:131], v[156:159], v[64:79]
    ds_read_b64_tr_b16 v[114:115], v152 offset:512
    v_lshlrev_b32 v36, 16, v102
    v_and_b32 v37, 0xffff0000, v102
    v_fmac_f32 v14, v36, v36
    v_add_f32 v22, v22, v36
    v_fmac_f32 v15, v37, v37
    v_add_f32 v23, v23, v37
    s_waitcnt lgkmcnt(8)
    v_mfma_f32_32x32x16_bf16 v[48:63], v[136:139], v[92:95], v[48:63]
    ds_read_b128 v[84:87], v149 offset:0
    ds_read_b64_tr_b16 v[120:121], v152 offset:2048
    ds_read_b64_tr_b16 v[122:123], v152 offset:2560
    s_add_u32 s86, s88, 4
    s_and_b32 s86, s86, 7
    s_lshl_b32 s85, s86, 7
    s_add_u32 s85, s85, s80
    s_add_u32 m0, s78, 0
    s_mul_i32 s86, s86, 196608
    buffer_load_dwordx4 v2, s[4:7], s85 offen lds
    s_add_u32 m0, s78, 8192
    s_add_u32 s85, s77, s86
    buffer_load_dwordx4 v3, s[8:11], s85 offen lds
    s_add_u32 m0, s78, 16384
    s_nop 0
    buffer_load_dwordx4 v4, s[8:11], s85 offen lds
    s_add_u32 m0, s78, 24576
    s_nop 0
    buffer_load_dwordx4 v5, s[8:11], s85 offen lds
    v_lshlrev_b32 v38, 16, v103
    v_mfma_f32_32x32x16_bf16 v[64:79], v[136:139], v[156:159], v[64:79]
    v_and_b32 v39, 0xffff0000, v103
    v_fmac_f32 v14, v38, v38
    v_add_f32 v22, v22, v38
    v_fmac_f32 v15, v39, v39
    v_add_f32 v23, v23, v39
    s_waitcnt lgkmcnt(3)
    v_mfma_f32_32x32x16_bf16 v[48:63], v[112:115], v[80:83], v[48:63]
    ds_read_b128 v[88:91], v150 offset:0
    ds_read_b64_tr_b16 v[128:129], v152 offset:4096
    ds_read_b64_tr_b16 v[130:131], v152 offset:4608
    v_mfma_f32_32x32x16_bf16 v[64:79], v[112:115], v[156:159], v[64:79]
    v_lshlrev_b32 v36, 16, v96
    v_and_b32 v37, 0xffff0000, v96
    v_fmac_f32 v14, v36, v36
    v_mfma_f32_32x32x16_bf16 v[160:175], v[156:159], v[176:179], v[160:175]
    v_add_f32 v22, v22, v36
    v_fmac_f32 v15, v37, v37
    v_add_f32 v23, v23, v37
    s_waitcnt lgkmcnt(3)
    v_mfma_f32_32x32x16_bf16 v[48:63], v[120:123], v[84:87], v[48:63]
    ds_read_b128 v[92:95], v151 offset:0
    ds_read_b64_tr_b16 v[136:137], v152 offset:6144
    ds_read_b64_tr_b16 v[138:139], v152 offset:6656
    v_mfma_f32_32x32x16_bf16 v[64:79], v[120:123], v[156:159], v[64:79]
    v_lshlrev_b32 v38, 16, v97
    v_and_b32 v39, 0xffff0000, v97
    v_fmac_f32 v14, v38, v38
    v_mfma_f32_32x32x16_bf16 v[160:175], v[156:159], v[180:183], v[160:175]
    v_add_f32 v22, v22, v38
    v_fmac_f32 v15, v39, v39
    v_add_f32 v23, v23, v39
    s_waitcnt vmcnt(4) lgkmcnt(3)
    s_barrier
    v_mfma_f32_32x32x16_bf16 v[48:63], v[128:131], v[88:91], v[48:63]
    ds_read_b128 v[100:103], v154 offset:32768
    ds_read_b64_tr_b16 v[184:185], v155 offset:32768
    ds_read_b64_tr_b16 v[186:187], v155 offset:33280
    ds_read_b64_tr_b16 v[188:189], v155 offset:34816
    ds_read_b64_tr_b16 v[190:191], v155 offset:35328
    ds_read_b128 v[80:83], v148 offset:32768
    ds_read_b64_tr_b16 v[112:113], v152 offset:32768
    v_mfma_f32_32x32x16_bf16 v[64:79], v[128:131], v[156:159], v[64:79]
    ds_read_b64_tr_b16 v[114:115], v152 offset:33280
    v_lshlrev_b32 v36, 16, v98
    v_and_b32 v37, 0xffff0000, v98
    v_fmac_f32 v14, v36, v36
    v_add_f32 v22, v22, v36
    v_fmac_f32 v15, v37, v37
    v_add_f32 v23, v23, v37
    s_waitcnt lgkmcnt(8)
    v_mfma_f32_32x32x16_bf16 v[48:63], v[136:139], v[92:95], v[48:63]
    ds_read_b128 v[84:87], v149 offset:32768
    ds_read_b64_tr_b16 v[120:121], v152 offset:34816
    ds_read_b64_tr_b16 v[122:123], v152 offset:35328
    s_add_u32 s86, s88, 5
    s_and_b32 s86, s86, 7
    s_lshl_b32 s85, s86, 7
    s_add_u32 s85, s85, s80
    s_add_u32 m0, s78, 32768
    s_mul_i32 s86, s86, 196608
    buffer_load_dwordx4 v2, s[4:7], s85 offen lds
    s_add_u32 m0, s78, 40960
    s_add_u32 s85, s77, s86
    buffer_load_dwordx4 v3, s[8:11], s85 offen lds
    s_add_u32 m0, s78, 49152
    s_nop 0
    buffer_load_dwordx4 v4, s[8:11], s85 offen lds
    s_add_u32 m0, s78, 57344
    s_nop 0
    buffer_load_dwordx4 v5, s[8:11], s85 offen lds
    v_lshlrev_b32 v38, 16, v99
    v_mfma_f32_32x32x16_bf16 v[64:79], v[136:139], v[156:159], v[64:79]
    v_and_b32 v39, 0xffff0000, v99
    v_fmac_f32 v14, v38, v38
    v_add_f32 v22, v22, v38
    v_fmac_f32 v15, v39, v39
    v_add_f32 v23, v23, v39
    s_waitcnt lgkmcnt(3)
    v_mfma_f32_32x32x16_bf16 v[48:63], v[112:115], v[80:83], v[48:63]
    ds_read_b128 v[88:91], v150 offset:32768
    ds_read_b64_tr_b16 v[128:129], v152 offset:36864
    ds_read_b64_tr_b16 v[130:131], v152 offset:37376
    v_mfma_f32_32x32x16_bf16 v[64:79], v[112:115], v[156:159], v[64:79]
    v_lshlrev_b32 v36, 16, v100
    v_and_b32 v37, 0xffff0000, v100
    v_fmac_f32 v14, v36, v36
    v_mfma_f32_32x32x16_bf16 v[160:175], v[156:159], v[184:187], v[160:175]
    v_add_f32 v22, v22, v36
    v_fmac_f32 v15, v37, v37
    v_add_f32 v23, v23, v37
    s_waitcnt lgkmcnt(3)
    v_mfma_f32_32x32x16_bf16 v[48:63], v[120:123], v[84:87], v[48:63]
    ds_read_b128 v[92:95], v151 offset:32768
    ds_read_b64_tr_b16 v[136:137], v152 offset:38912
    ds_read_b64_tr_b16 v[138:139], v152 offset:39424
    v_mfma_f32_32x32x16_bf16 v[64:79], v[120:123], v[156:159], v[64:79]
    v_lshlrev_b32 v38, 16, v101
    v_and_b32 v39, 0xffff0000, v101
    v_fmac_f32 v14, v38, v38
    v_mfma_f32_32x32x16_bf16 v[160:175], v[156:159], v[188:191], v[160:175]
    v_add_f32 v22, v22, v38
    v_fmac_f32 v15, v39, v39
    v_add_f32 v23, v23, v39
    s_waitcnt vmcnt(4) lgkmcnt(3)
    s_barrier
    v_mfma_f32_32x32x16_bf16 v[48:63], v[128:131], v[88:91], v[48:63]
    ds_read_b128 v[96:99], v7 offset:0
    ds_read_b64_tr_b16 v[176:177], v6 offset:0
    ds_read_b64_tr_b16 v[178:179], v6 offset:512
    ds_read_b64_tr_b16 v[180:181], v6 offset:2048
    ds_read_b64_tr_b16 v[182:183], v6 offset:2560
    ds_read_b128 v[80:83], v8 offset:0
    ds_read_b64_tr_b16 v[112:113], v12 offset:0
    v_mfma_f32_32x32x16_bf16 v[64:79], v[128:131], v[156:159], v[64:79]
    ds_read_b64_tr_b16 v[114:115], v12 offset:512
    v_lshlrev_b32 v36, 16, v102
    v_and_b32 v37, 0xffff0000, v102
    v_fmac_f32 v14, v36, v36
    v_add_f32 v22, v22, v36
    v_fmac_f32 v15, v37, v37
    v_add_f32 v23, v23, v37
    s_waitcnt lgkmcnt(8)
    v_mfma_f32_32x32x16_bf16 v[48:63], v[136:139], v[92:95], v[48:63]
    ds_read_b128 v[84:87], v9 offset:0
    ds_read_b64_tr_b16 v[120:121], v12 offset:2048
    ds_read_b64_tr_b16 v[122:123], v12 offset:2560
    s_add_u32 s86, s88, 6
    s_and_b32 s86, s86, 7
    s_lshl_b32 s85, s86, 7
    s_add_u32 s85, s85, s80
    s_add_u32 m0, s78, 65536
    s_mul_i32 s86, s86, 196608
    buffer_load_dwordx4 v2, s[4:7], s85 offen lds
    s_add_u32 m0, s78, 73728
    s_add_u32 s85, s77, s86
    buffer_load_dwordx4 v3, s[8:11], s85 offen lds
    s_add_u32 m0, s78, 81920
    s_nop 0
    buffer_load_dwordx4 v4, s[8:11], s85 offen lds
    s_add_u32 m0, s78, 90112
    s_nop 0
    buffer_load_dwordx4 v5, s[8:11], s85 offen lds
    v_lshlrev_b32 v38, 16, v103
    v_mfma_f32_32x32x16_bf16 v[64:79], v[136:139], v[156:159], v[64:79]
    v_and_b32 v39, 0xffff0000, v103
    v_fmac_f32 v14, v38, v38
    v_add_f32 v22, v22, v38
    v_fmac_f32 v15, v39, v39
    v_add_f32 v23, v23, v39
    s_waitcnt lgkmcnt(3)
    v_mfma_f32_32x32x16_bf16 v[48:63], v[112:115], v[80:83], v[48:63]
    ds_read_b128 v[88:91], v10 offset:0
    ds_read_b64_tr_b16 v[128:129], v12 offset:4096
    ds_read_b64_tr_b16 v[130:131], v12 offset:4608
    v_mfma_f32_32x32x16_bf16 v[64:79], v[112:115], v[156:159], v[64:79]
    v_lshlrev_b32 v36, 16, v96
    v_and_b32 v37, 0xffff0000, v96
    v_fmac_f32 v14, v36, v36
    v_mfma_f32_32x32x16_bf16 v[160:175], v[156:159], v[176:179], v[160:175]
    v_add_f32 v22, v22, v36
    v_fmac_f32 v15, v37, v37
    v_add_f32 v23, v23, v37
    s_waitcnt lgkmcnt(3)
    v_mfma_f32_32x32x16_bf16 v[48:63], v[120:123], v[84:87], v[48:63]
    ds_read_b128 v[92:95], v11 offset:0
    ds_read_b64_tr_b16 v[136:137], v12 offset:6144
    ds_read_b64_tr_b16 v[138:139], v12 offset:6656
    v_mfma_f32_32x32x16_bf16 v[64:79], v[120:123], v[156:159], v[64:79]
    v_lshlrev_b32 v38, 16, v97
    v_and_b32 v39, 0xffff0000, v97
    v_fmac_f32 v14, v38, v38
    v_mfma_f32_32x32x16_bf16 v[160:175], v[156:159], v[180:183], v[160:175]
    v_add_f32 v22, v22, v38
    v_fmac_f32 v15, v39, v39
    v_add_f32 v23, v23, v39
    s_waitcnt vmcnt(4) lgkmcnt(3)
    s_barrier
    v_mfma_f32_32x32x16_bf16 v[48:63], v[128:131], v[88:91], v[48:63]
    ds_read_b128 v[100:103], v7 offset:32768
    ds_read_b64_tr_b16 v[184:185], v6 offset:32768
    ds_read_b64_tr_b16 v[186:187], v6 offset:33280
    ds_read_b64_tr_b16 v[188:189], v6 offset:34816
    ds_read_b64_tr_b16 v[190:191], v6 offset:35328
    ds_read_b128 v[80:83], v8 offset:32768
    ds_read_b64_tr_b16 v[112:113], v12 offset:32768
    v_mfma_f32_32x32x16_bf16 v[64:79], v[128:131], v[156:159], v[64:79]
    ds_read_b64_tr_b16 v[114:115], v12 offset:33280
    v_lshlrev_b32 v36, 16, v98
    v_and_b32 v37, 0xffff0000, v98
    v_fmac_f32 v14, v36, v36
    v_add_f32 v22, v22, v36
    v_fmac_f32 v15, v37, v37
    v_add_f32 v23, v23, v37
    s_waitcnt lgkmcnt(8)
    v_mfma_f32_32x32x16_bf16 v[48:63], v[136:139], v[92:95], v[48:63]
    ds_read_b128 v[84:87], v9 offset:32768
    ds_read_b64_tr_b16 v[120:121], v12 offset:34816
    ds_read_b64_tr_b16 v[122:123], v12 offset:35328
    s_add_u32 s86, s88, 7
    s_and_b32 s86, s86, 7
    s_lshl_b32 s85, s86, 7
    s_add_u32 s85, s85, s80
    s_add_u32 m0, s78, 98304
    s_mul_i32 s86, s86, 196608
    buffer_load_dwordx4 v2, s[4:7], s85 offen lds
    s_add_u32 m0, s78, 106496
    s_add_u32 s85, s77, s86
    buffer_load_dwordx4 v3, s[8:11], s85 offen lds
    s_add_u32 m0, s78, 114688
    s_nop 0
    buffer_load_dwordx4 v4, s[8:11], s85 offen lds
    s_add_u32 m0, s78, 122880
    s_nop 0
    buffer_load_dwordx4 v5, s[8:11], s85 offen lds
    s_lshl_b32 s85, s42, 7
    s_add_u32 s85, s85, 65536
    v_and_b32 v28, 31, v253
    v_lshlrev_b32 v28, 2, v28
    buffer_load_dword v29, v28, s[12:15], s85 offen sc1
    v_lshlrev_b32 v38, 16, v99
    v_mfma_f32_32x32x16_bf16 v[64:79], v[136:139], v[156:159], v[64:79]
    v_and_b32 v39, 0xffff0000, v99
    v_fmac_f32 v14, v38, v38
    v_add_f32 v22, v22, v38
    v_fmac_f32 v15, v39, v39
    v_add_f32 v23, v23, v39
    s_waitcnt lgkmcnt(3)
    v_mfma_f32_32x32x16_bf16 v[48:63], v[112:115], v[80:83], v[48:63]
    ds_read_b128 v[88:91], v10 offset:32768
    ds_read_b64_tr_b16 v[128:129], v12 offset:36864
    ds_read_b64_tr_b16 v[130:131], v12 offset:37376
    v_mfma_f32_32x32x16_bf16 v[64:79], v[112:115], v[156:159], v[64:79]
    v_lshlrev_b32 v36, 16, v100
    v_and_b32 v37, 0xffff0000, v100
    v_fmac_f32 v14, v36, v36
    v_mfma_f32_32x32x16_bf16 v[160:175], v[156:159], v[184:187], v[160:175]
    v_add_f32 v22, v22, v36
    v_fmac_f32 v15, v37, v37
    v_add_f32 v23, v23, v37
    s_waitcnt lgkmcnt(3)
    v_mfma_f32_32x32x16_bf16 v[48:63], v[120:123], v[84:87], v[48:63]
    ds_read_b128 v[92:95], v11 offset:32768
    ds_read_b64_tr_b16 v[136:137], v12 offset:38912
    ds_read_b64_tr_b16 v[138:139], v12 offset:39424
    v_mfma_f32_32x32x16_bf16 v[64:79], v[120:123], v[156:159], v[64:79]
    v_lshlrev_b32 v38, 16, v101
    v_and_b32 v39, 0xffff0000, v101
    v_fmac_f32 v14, v38, v38
    v_mfma_f32_32x32x16_bf16 v[160:175], v[156:159], v[188:191], v[160:175]
    v_add_f32 v22, v22, v38
    v_fmac_f32 v15, v39, v39
    v_add_f32 v23, v23, v39
    s_waitcnt vmcnt(5) lgkmcnt(3)
    s_barrier
    v_mfma_f32_32x32x16_bf16 v[48:63], v[128:131], v[88:91], v[48:63]
    ds_read_b128 v[96:99], v154 offset:0
    ds_read_b64_tr_b16 v[176:177], v155 offset:0
    ds_read_b64_tr_b16 v[178:179], v155 offset:512
    ds_read_b64_tr_b16 v[180:181], v155 offset:2048
    ds_read_b64_tr_b16 v[182:183], v155 offset:2560
    ds_read_b128 v[80:83], v148 offset:0
    ds_read_b64_tr_b16 v[112:113], v152 offset:0
    v_mfma_f32_32x32x16_bf16 v[64:79], v[128:131], v[156:159], v[64:79]
    ds_read_b64_tr_b16 v[114:115], v152 offset:512
    v_lshlrev_b32 v36, 16, v102
    v_and_b32 v37, 0xffff0000, v102
    v_fmac_f32 v14, v36, v36
    v_add_f32 v22, v22, v36
    v_fmac_f32 v15, v37, v37
    v_add_f32 v23, v23, v37
    s_waitcnt lgkmcnt(8)
    v_mfma_f32_32x32x16_bf16 v[48:63], v[136:139], v[92:95], v[48:63]
    ds_read_b128 v[84:87], v149 offset:0
    ds_read_b64_tr_b16 v[120:121], v152 offset:2048
    ds_read_b64_tr_b16 v[122:123], v152 offset:2560
    v_lshlrev_b32 v38, 16, v103
    v_and_b32 v39, 0xffff0000, v103
    v_mfma_f32_32x32x16_bf16 v[64:79], v[136:139], v[156:159], v[64:79]
    v_fmac_f32 v14, v38, v38
    v_add_f32 v22, v22, v38
    v_fmac_f32 v15, v39, v39
    v_add_f32 v23, v23, v39
    s_waitcnt lgkmcnt(3)
    v_mfma_f32_32x32x16_bf16 v[48:63], v[112:115], v[80:83], v[48:63]
    ds_read_b128 v[88:91], v150 offset:0
    ds_read_b64_tr_b16 v[128:129], v152 offset:4096
    ds_read_b64_tr_b16 v[130:131], v152 offset:4608
    v_mfma_f32_32x32x16_bf16 v[64:79], v[112:115], v[156:159], v[64:79]
    v_lshlrev_b32 v36, 16, v96
    v_and_b32 v37, 0xffff0000, v96
    v_fmac_f32 v14, v36, v36
    v_mfma_f32_32x32x16_bf16 v[160:175], v[156:159], v[176:179], v[160:175]
    v_add_f32 v22, v22, v36
    v_fmac_f32 v15, v37, v37
    v_add_f32 v23, v23, v37
    s_waitcnt lgkmcnt(3)
    v_mfma_f32_32x32x16_bf16 v[48:63], v[120:123], v[84:87], v[48:63]
    ds_read_b128 v[92:95], v151 offset:0
    ds_read_b64_tr_b16 v[136:137], v152 offset:6144
    ds_read_b64_tr_b16 v[138:139], v152 offset:6656
    v_mfma_f32_32x32x16_bf16 v[64:79], v[120:123], v[156:159], v[64:79]
    v_lshlrev_b32 v38, 16, v97
    v_and_b32 v39, 0xffff0000, v97
    v_fmac_f32 v14, v38, v38
    v_mfma_f32_32x32x16_bf16 v[160:175], v[156:159], v[180:183], v[160:175]
    v_add_f32 v22, v22, v38
    v_fmac_f32 v15, v39, v39
    v_add_f32 v23, v23, v39
    s_waitcnt vmcnt(1) lgkmcnt(3)
    s_barrier
    v_mfma_f32_32x32x16_bf16 v[48:63], v[128:131], v[88:91], v[48:63]
    ds_read_b128 v[100:103], v154 offset:32768
    ds_read_b64_tr_b16 v[184:185], v155 offset:32768
    ds_read_b64_tr_b16 v[186:187], v155 offset:33280
    ds_read_b64_tr_b16 v[188:189], v155 offset:34816
    ds_read_b64_tr_b16 v[190:191], v155 offset:35328
    ds_read_b128 v[80:83], v148 offset:32768
    ds_read_b64_tr_b16 v[112:113], v152 offset:32768
    v_mfma_f32_32x32x16_bf16 v[64:79], v[128:131], v[156:159], v[64:79]
    ds_read_b64_tr_b16 v[114:115], v152 offset:33280
    v_lshlrev_b32 v36, 16, v98
    v_and_b32 v37, 0xffff0000, v98
    v_fmac_f32 v14, v36, v36
    v_add_f32 v22, v22, v36
    v_fmac_f32 v15, v37, v37
    v_add_f32 v23, v23, v37
    s_waitcnt lgkmcnt(8)
    v_mfma_f32_32x32x16_bf16 v[48:63], v[136:139], v[92:95], v[48:63]
    ds_read_b128 v[84:87], v149 offset:32768
    ds_read_b64_tr_b16 v[120:121], v152 offset:34816
    ds_read_b64_tr_b16 v[122:123], v152 offset:35328
    v_lshlrev_b32 v38, 16, v99
    v_and_b32 v39, 0xffff0000, v99
    v_mfma_f32_32x32x16_bf16 v[64:79], v[136:139], v[156:159], v[64:79]
    v_fmac_f32 v14, v38, v38
    v_add_f32 v22, v22, v38
    v_fmac_f32 v15, v39, v39
    v_add_f32 v23, v23, v39
    s_waitcnt lgkmcnt(3)
    v_mfma_f32_32x32x16_bf16 v[48:63], v[112:115], v[80:83], v[48:63]
    ds_read_b128 v[88:91], v150 offset:32768
    ds_read_b64_tr_b16 v[128:129], v152 offset:36864
    ds_read_b64_tr_b16 v[130:131], v152 offset:37376
    v_mfma_f32_32x32x16_bf16 v[64:79], v[112:115], v[156:159], v[64:79]
    v_lshlrev_b32 v36, 16, v100
    v_and_b32 v37, 0xffff0000, v100
    v_fmac_f32 v14, v36, v36
    v_mfma_f32_32x32x16_bf16 v[160:175], v[156:159], v[184:187], v[160:175]
    v_add_f32 v22, v22, v36
    v_fmac_f32 v15, v37, v37
    v_add_f32 v23, v23, v37
    s_waitcnt lgkmcnt(3)
    v_mfma_f32_32x32x16_bf16 v[48:63], v[120:123], v[84:87], v[48:63]
    ds_read_b128 v[92:95], v151 offset:32768
    ds_read_b64_tr_b16 v[136:137], v152 offset:38912
    ds_read_b64_tr_b16 v[138:139], v152 offset:39424
    v_mfma_f32_32x32x16_bf16 v[64:79], v[120:123], v[156:159], v[64:79]
    v_lshlrev_b32 v38, 16, v101
    v_and_b32 v39, 0xffff0000, v101
    v_fmac_f32 v14, v38, v38
    v_mfma_f32_32x32x16_bf16 v[160:175], v[156:159], v[188:191], v[160:175]
    v_add_f32 v22, v22, v38
    v_fmac_f32 v15, v39, v39
    v_add_f32 v23, v23, v39
    s_waitcnt lgkmcnt(3)
    v_mfma_f32_32x32x16_bf16 v[48:63], v[128:131], v[88:91], v[48:63]
    v_lshlrev_b32 v36, 16, v102
    v_and_b32 v37, 0xffff0000, v102
    v_fmac_f32 v14, v36, v36
    v_mfma_f32_32x32x16_bf16 v[64:79], v[128:131], v[156:159], v[64:79]
    v_add_f32 v22, v22, v36
    v_fmac_f32 v15, v37, v37
    v_add_f32 v23, v23, v37
    s_waitcnt lgkmcnt(0)
    v_mfma_f32_32x32x16_bf16 v[48:63], v[136:139], v[92:95], v[48:63]
    v_lshlrev_b32 v38, 16, v103
    v_and_b32 v39, 0xffff0000, v103
    v_fmac_f32 v14, v38, v38
    v_mfma_f32_32x32x16_bf16 v[64:79], v[136:139], v[156:159], v[64:79]
    v_add_f32 v22, v22, v38
    v_fmac_f32 v15, v39, v39
    v_add_f32 v23, v23, v39
L_p1_joined:
    v_lshrrev_b32 v21, 5, v253
    v_add_f32 v22, v22, v23
    v_add_f32 v16, v14, v15
    v_and_b32 v25, 31, v253
    v_mov_b32 v23, v22
    v_mov_b32 v17, v16
    v_lshlrev_b32 v25, 2, v25
    s_lshl_b32 s85, s51, 10
    v_permlane32_swap_b32 v22, v23
    v_permlane32_swap_b32 v16, v17
    s_add_u32 s85, s85, 135168
    v_lshl_add_u32 v26, v25, 1, s85
    s_lshl_b32 s86, s3, 8
    v_add_u32 v27, s86, v26
    v_add_f32 v22, v22, v23
    v_add_f32 v23, v16, v17
    s_mov_b64 exec, 0xffffffff
    ds_write_b64 v27, v[22:23]
    s_and_b32 s86, s3, 1
    s_cmp_eq_u32 s86, s51
    s_cbranch_scc1 L_p1_e1
    s_lshl_b32 s85, s3, 7
    s_add_u32 s85, s85, 131584
    v_add_u32 v27, s85, v25
    ds_write_b32 v27, v160
    s_lshl_b32 s85, s3, 7
    s_add_u32 s85, s85, 131072
    s_mov_b64 exec, -1
    v_lshlrev_b32 v27, 4, v21
    v_add_u32 v27, s85, v27
    s_mov_b32 exec_lo, 1
    s_mov_b32 exec_hi, 1
    ds_write_b128 v27, v[64:67] offset:0
    ds_write_b128 v27, v[68:71] offset:32
    ds_write_b128 v27, v[72:75] offset:64
    ds_write_b128 v27, v[76:79] offset:96
L_p1_e1:
    s_mov_b64 exec, -1
    s_lshl_b32 s85, s42, 7
    s_add_u32 s85, s85, 65536
    s_add_u32 s86, s45, 1
    s_mov_b32 s87, 0
    s_waitcnt vmcnt(0)
L_p1_hchk:
    v_subrev_u32 v29, s86, v29
    v_cmp_lt_u32 vcc, 15, v29
    s_cbranch_vccz L_p1_hok
    s_add_u32 s87, s87, 1
    s_cmp_gt_u32 s87, 0x100000
    s_cbranch_scc1 L_p1_hok
    buffer_load_dword v29, v28, s[12:15], s85 offen sc1
    s_waitcnt vmcnt(0)
    s_branch L_p1_hchk
L_p1_hok:
    v_cmp_ne_u32 vcc, s75, v29
    s_cmp_eq_u64 vcc, 0
    s_cselect_b32 s46, 1, 0
    s_waitcnt lgkmcnt(0)
    s_barrier
    ds_read_b64 v[36:37], v26 offset:0
    ds_read_b64 v[38:39], v26 offset:256
    ds_read_b64 v[40:41], v26 offset:512
    ds_read_b64 v[42:43], v26 offset:768
    s_lshl_b32 s85, s3, 7
    s_add_u32 s85, s85, 131072
    v_lshlrev_b32 v20, 4, v21
    v_add_u32 v20, s85, v20
    ds_read_b128 v[80:83], v20 offset:0
    ds_read_b128 v[84:87], v20 offset:32
    ds_read_b128 v[88:91], v20 offset:64
    ds_read_b128 v[92:95], v20 offset:96
    s_and_b32 s85, s3, 2
    s_lshl_b32 s85, s85, 7
    s_add_u32 s85, s85, 131584
    v_add_u32 v27, s85, v25
    ds_read_b32 v19, v27
    ds_read_b32 v18, v27 offset:128
    s_waitcnt lgkmcnt(6)
    v_pk_add_f32 v[36:37], v[36:37], v[38:39]
    v_pk_add_f32 v[40:41], v[40:41], v[42:43]
    v_pk_add_f32 v[36:37], v[36:37], v[40:41]
    v_mul_f32 v14, 0x3b000000, v36
    v_mul_f32 v16, 0x3b000000, v37
    v_fma_f32 v16, -v14, v14, v16
    v_add_f32 v16, 0x3727c5ac, v16
    v_rsq_f32 v16, v16
    s_lshl_b32 s85, s44, 8
    s_add_u32 s85, s85, 132096
    v_add_u32 v25, s85, v25
    v_mul_f32 v17, v14, v16
    v_mul_f32 v15, 0x3eb8aa3b, v16
    v_lshlrev_b32 v23, 4, v21
    v_add_u32 v23, s85, v23
    ds_write_b32 v25, v16
    ds_write_b32 v25, v17 offset:128
    s_waitcnt lgkmcnt(2)
    v_add_f32 v19, v19, v18
    v_pk_fma_f32 v[56:57], v[88:89], v[14:15], v[56:57] op_sel_hi:[1,0,1] neg_lo:[0,1,0] neg_hi:[0,1,0]
    v_pk_fma_f32 v[58:59], v[90:91], v[14:15], v[58:59] op_sel_hi:[1,0,1] neg_lo:[0,1,0] neg_hi:[0,1,0]
    v_pk_fma_f32 v[60:61], v[92:93], v[14:15], v[60:61] op_sel_hi:[1,0,1] neg_lo:[0,1,0] neg_hi:[0,1,0]
    v_pk_fma_f32 v[62:63], v[94:95], v[14:15], v[62:63] op_sel_hi:[1,0,1] neg_lo:[0,1,0] neg_hi:[0,1,0]
    v_pk_mul_f32 v[56:57], v[56:57], v[16:17] op_sel_hi:[1,0]
    v_pk_mul_f32 v[58:59], v[58:59], v[16:17] op_sel_hi:[1,0]
    v_pk_mul_f32 v[60:61], v[60:61], v[16:17] op_sel_hi:[1,0]
    v_pk_mul_f32 v[62:63], v[62:63], v[16:17] op_sel_hi:[1,0]
    v_cvt_pk_bf16_f32 v28, v56, v57
    v_cvt_pk_bf16_f32 v29, v58, v59
    v_cvt_pk_bf16_f32 v30, v60, v61
    v_cvt_pk_bf16_f32 v31, v62, v63
    s_cmp_eq_u32 s46, 0
    s_cbranch_scc1 L_p1s_k_s
    buffer_store_dwordx4 v[28:31], v252, s[12:15], s93 offen
    s_branch L_p1s_k_d
L_p1s_k_s:
    buffer_store_dwordx4 v[28:31], v252, s[12:15], s93 offen sc1
L_p1s_k_d:
    s_waitcnt lgkmcnt(0)
    ds_read_b128 v[96:99], v23 offset:0
    ds_read_b128 v[112:115], v23 offset:128
    ds_read_b128 v[100:103], v23 offset:32
    ds_read_b128 v[116:119], v23 offset:160
    ds_read_b128 v[104:107], v23 offset:64
    ds_read_b128 v[120:123], v23 offset:192
    ds_read_b128 v[108:111], v23 offset:96
    ds_read_b128 v[124:127], v23 offset:224
    v_pk_fma_f32 v[48:49], v[80:81], v[14:15], v[48:49] op_sel_hi:[1,0,1] neg_lo:[0,1,0] neg_hi:[0,1,0]
    v_pk_fma_f32 v[50:51], v[82:83], v[14:15], v[50:51] op_sel_hi:[1,0,1] neg_lo:[0,1,0] neg_hi:[0,1,0]
    v_pk_fma_f32 v[52:53], v[84:85], v[14:15], v[52:53] op_sel_hi:[1,0,1] neg_lo:[0,1,0] neg_hi:[0,1,0]
    v_pk_fma_f32 v[54:55], v[86:87], v[14:15], v[54:55] op_sel_hi:[1,0,1] neg_lo:[0,1,0] neg_hi:[0,1,0]
    v_pk_mul_f32 v[48:49], v[48:49], v[14:15] op_sel:[0,1] op_sel_hi:[1,1]
    v_pk_mul_f32 v[50:51], v[50:51], v[14:15] op_sel:[0,1] op_sel_hi:[1,1]
    v_pk_mul_f32 v[52:53], v[52:53], v[14:15] op_sel:[0,1] op_sel_hi:[1,1]
    v_pk_mul_f32 v[54:55], v[54:55], v[14:15] op_sel:[0,1] op_sel_hi:[1,1]
    v_cvt_pk_bf16_f32 v32, v48, v49
    v_cvt_pk_bf16_f32 v33, v50, v51
    v_cvt_pk_bf16_f32 v34, v52, v53
    v_cvt_pk_bf16_f32 v35, v54, v55
    s_cmp_eq_u32 s46, 0
    s_cbranch_scc1 L_p1s_q_s
    buffer_store_dwordx4 v[32:35], v252, s[12:15], s92 offen
    s_branch L_p1s_q_d
L_p1s_q_s:
    buffer_store_dwordx4 v[32:35], v252, s[12:15], s92 offen sc1
L_p1s_q_d:
    s_sub_u32 s89, s93, 0x20000
    s_sub_u32 s90, s94, 0x20000
    s_and_b32 s86, s3, 1
    s_cmp_eq_u32 s86, s51
    s_cbranch_scc0 L_p1_st_n
    s_waitcnt lgkmcnt(0)
    v_pk_mul_f32 v[112:113], v[112:113], v[18:19] op_sel:[0,1] op_sel_hi:[1,1]
    v_pk_mul_f32 v[114:115], v[114:115], v[18:19] op_sel:[0,1] op_sel_hi:[1,1]
    v_pk_mul_f32 v[116:117], v[116:117], v[18:19] op_sel:[0,1] op_sel_hi:[1,1]
    v_pk_mul_f32 v[118:119], v[118:119], v[18:19] op_sel:[0,1] op_sel_hi:[1,1]
    v_pk_fma_f32 v[64:65], v[64:65], v[96:97], v[112:113] neg_lo:[0,0,1] neg_hi:[0,0,1]
    v_pk_fma_f32 v[66:67], v[66:67], v[98:99], v[114:115] neg_lo:[0,0,1] neg_hi:[0,0,1]
    v_pk_fma_f32 v[68:69], v[68:69], v[100:101], v[116:117] neg_lo:[0,0,1] neg_hi:[0,0,1]
    v_pk_fma_f32 v[70:71], v[70:71], v[102:103], v[118:119] neg_lo:[0,0,1] neg_hi:[0,0,1]
    v_cvt_pk_bf16_f32 v40, v64, v65
    v_cvt_pk_bf16_f32 v41, v66, v67
    v_cvt_pk_bf16_f32 v42, v68, v69
    v_cvt_pk_bf16_f32 v43, v70, v71
    s_cmp_eq_u32 s46, 0
    s_cbranch_scc1 L_p1s_v0_s
    buffer_store_dwordx4 v[40:43], v144, s[12:15], s89 offen offset:0
    s_branch L_p1s_v0_d
L_p1s_v0_s:
    buffer_store_dwordx4 v[40:43], v144, s[12:15], s89 offen offset:0 sc1
L_p1s_v0_d:
    v_pk_mul_f32 v[120:121], v[120:121], v[18:19] op_sel:[0,1] op_sel_hi:[1,1]
    v_pk_mul_f32 v[122:123], v[122:123], v[18:19] op_sel:[0,1] op_sel_hi:[1,1]
    v_pk_mul_f32 v[124:125], v[124:125], v[18:19] op_sel:[0,1] op_sel_hi:[1,1]
    v_pk_mul_f32 v[126:127], v[126:127], v[18:19] op_sel:[0,1] op_sel_hi:[1,1]
    v_pk_fma_f32 v[72:73], v[72:73], v[104:105], v[120:121] neg_lo:[0,0,1] neg_hi:[0,0,1]
    v_pk_fma_f32 v[74:75], v[74:75], v[106:107], v[122:123] neg_lo:[0,0,1] neg_hi:[0,0,1]
    v_pk_fma_f32 v[76:77], v[76:77], v[108:109], v[124:125] neg_lo:[0,0,1] neg_hi:[0,0,1]
    v_pk_fma_f32 v[78:79], v[78:79], v[110:111], v[126:127] neg_lo:[0,0,1] neg_hi:[0,0,1]
    v_cvt_pk_bf16_f32 v44, v72, v73
    v_cvt_pk_bf16_f32 v45, v74, v75
    v_cvt_pk_bf16_f32 v46, v76, v77
    v_cvt_pk_bf16_f32 v47, v78, v79
    s_cmp_eq_u32 s46, 0
    s_cbranch_scc1 L_p1s_v1_s
    buffer_store_dwordx4 v[44:47], v144, s[12:15], s89 offen offset:512
    s_branch L_p1s_v1_d
L_p1s_v1_s:
    buffer_store_dwordx4 v[44:47], v144, s[12:15], s89 offen offset:512 sc1
L_p1s_v1_d:
    buffer_store_dwordx4 v[28:31], v252, s[12:15], s94 offen sc1
    buffer_store_dwordx4 v[40:43], v144, s[12:15], s90 offen sc1
    buffer_store_dwordx4 v[44:47], v144, s[12:15], s90 offen offset:512 sc1
    s_waitcnt vmcnt(3)
    s_branch L_p1_st_done
L_p1_st_n:
    buffer_store_dwordx4 v[28:31], v252, s[12:15], s94 offen sc1
    s_waitcnt vmcnt(1) lgkmcnt(0)
L_p1_st_done:
    s_lshl_b32 s85, s42, 10
    s_add_u32 s85, s85, 73728
    s_lshl_b32 s86, s43, 3
    s_add_u32 s86, s86, s44
    s_lshl_b32 s86, s86, 2
    s_add_u32 s86, s86, s85
    v_mov_b32 v2, s45
    v_mov_b32 v3, 0
    s_mov_b64 exec, 1
    s_cmp_eq_u32 s46, 0
    s_cbranch_scc1 L_tf_p1_s
    buffer_store_dword v2, v3, s[12:15], s86 offen
    s_branch L_tf_p1_d
L_tf_p1_s:
    buffer_store_dword v2, v3, s[12:15], s86 offen sc1
L_tf_p1_d:
    s_mov_b64 exec, -1
    s_lshl_b32 s86, s100, 7
    s_add_u32 s85, s85, s86
    s_lshl_b32 s89, s43, 3
    s_add_u32 s89, s89, s42
    s_cmp_ge_u32 s44, 4
    s_cbranch_scc1 L3_hw_start
    s_lshl_b32 s90, s89, 13
    s_lshl_b32 s88, s44, 11
    s_add_u32 s90, s90, s88
    s_add_u32 s90, s90, 16777216
    v_mov_b32 v144, v252
    v_and_b32 v4, 15, v253
    v_lshlrev_b32 v4, 4, v4
    v_lshrrev_b32 v5, 5, v253
    v_lshl_add_u32 v4, v5, 8, v4
    v_add_u32 v4, 8192, v4
    v_and_b32 v5, 31, v253
    v_subrev_u32 v6, 20, v5
    v_cmp_gt_u32 vcc, 8, v6
    v_mov_b32 v7, 155664
    v_mov_b32 v6, 155728
    v_cndmask_b32 v7, v7, v6, vcc
    v_cmp_eq_u32 vcc, 16, v5
    v_mov_b32 v6, 155648
    s_nop 0
    v_cndmask_b32 v7, v7, v6, vcc
    v_cmp_gt_u32 vcc, 16, v5
    v_mov_b32 v6, 16384
    s_nop 0
    v_cndmask_b32 v145, v7, v4, vcc
    v_cndmask_b32 v146, 0, v6, vcc
    v_mov_b32 v80, 0
    v_mov_b32 v81, 0
    v_mov_b32 v82, 0
    v_mov_b32 v83, 0
    v_mov_b32 v84, 0
    v_mov_b32 v85, 0
    v_mov_b32 v86, 0
    v_mov_b32 v87, 0
    v_mov_b32 v88, 0
    v_mov_b32 v89, 0
    v_mov_b32 v90, 0
    v_mov_b32 v91, 0
    v_mov_b32 v92, 0
    v_mov_b32 v93, 0
    v_mov_b32 v94, 0
    v_mov_b32 v95, 0
    v_mov_b32 v96, 0
    v_mov_b32 v97, 0
    v_mov_b32 v98, 0
    v_mov_b32 v99, 0
    v_mov_b32 v100, 0
    v_mov_b32 v101, 0
    v_mov_b32 v102, 0
    v_mov_b32 v103, 0
    v_mov_b32 v104, 0
    v_mov_b32 v105, 0
    v_mov_b32 v106, 0
    v_mov_b32 v107, 0
    v_mov_b32 v108, 0
    v_mov_b32 v109, 0
    v_mov_b32 v110, 0
    v_mov_b32 v111, 0
    v_mov_b32 v112, 0
    v_mov_b32 v113, 0
    v_mov_b32 v114, 0
    v_mov_b32 v115, 0
    v_mov_b32 v116, 0
    v_mov_b32 v117, 0
    v_mov_b32 v118, 0
    v_mov_b32 v119, 0
    v_mov_b32 v128, 0
    v_mov_b32 v129, 0
    v_mov_b32 v130, 0
    v_mov_b32 v131, 0
    v_mov_b32 v132, 0
    v_mov_b32 v133, 0
    v_mov_b32 v134, 0
    v_mov_b32 v135, 0
    v_mov_b32 v136, 0
    v_mov_b32 v137, 0
    v_mov_b32 v138, 0
    v_mov_b32 v139, 0
    v_mov_b32 v140, 0
    v_mov_b32 v141, 0
    v_mov_b32 v142, 0
    v_mov_b32 v143, 0
    v_and_b32 v2, 31, v253
    v_lshlrev_b32 v2, 2, v2
    s_mov_b32 s95, 0
L_poll_p1c:
    buffer_load_dword v3, v2, s[12:15], s85 offen sc1
    s_add_u32 s95, s95, 1
    s_waitcnt vmcnt(0)
    v_cmp_ne_u32 vcc, s45, v3
    s_cmp_gt_u32 s95, 0x100000
    s_cbranch_scc1 L_poll_p1c_x
    s_cbranch_vccnz L_poll_p1c
L_poll_p1c_x:
    buffer_load_dwordx4 v[240:243], v252, s[12:15], s90 offen sc1
    buffer_load_dwordx4 v[244:247], v252, s[12:15], s90 offen offset:1024 sc1
    s_lshl_b32 s80, s42, 8
    s_lshr_b32 s81, s43, 3
    s_lshl_b32 s81, s81, 6
    s_add_u32 s80, s80, s81
    s_and_b32 s81, s44, 1
    s_lshl_b32 s81, s81, 5
    s_add_u32 s80, s80, s81
    s_lshl_b32 s80, s80, 10
    s_and_b32 s81, s43, 7
    s_lshl_b32 s81, s81, 7
    s_add_u32 s80, s80, s81
    s_lshr_b32 s81, s44, 1
    s_lshl_b32 s81, s81, 6
    s_add_u32 s80, s80, s81
    v_and_b32 v2, 31, v253
    v_lshlrev_b32 v2, 10, v2
    v_lshrrev_b32 v3, 5, v253
    v_lshl_add_u32 v2, v3, 3, v2
    buffer_load_dwordx2 v[148:149], v2, s[4:7], s80 offen offset:0
    buffer_load_dwordx2 v[150:151], v2, s[4:7], s80 offen offset:16
    buffer_load_dwordx2 v[152:153], v2, s[4:7], s80 offen offset:32
    buffer_load_dwordx2 v[154:155], v2, s[4:7], s80 offen offset:48
    s_lshl_b32 s85, s43, 3
    s_add_u32 s85, s85, s44
    s_lshl_b32 s85, s85, 5
    s_lshl_b32 s86, s42, 2
    s_add_u32 s85, s85, s86
    s_add_u32 s85, s85, 4096
    v_mov_b32 v2, s45
    v_mov_b32 v3, 0
    s_mov_b64 exec, 1
    buffer_store_dword v2, v3, s[12:15], s85 offen sc1
    s_mov_b64 exec, -1
    s_waitcnt vmcnt(5)
    s_barrier
    ds_read_b128 v[120:123], v144
    ds_read_b128 v[128:131], v145
    ds_read_b128 v[132:135], v145 offset:512
    s_waitcnt lgkmcnt(2)
    v_mfma_f32_32x32x16_bf16 v[16:31], v[120:123], v[240:243], 0
    v_mfma_f32_32x32x16_bf16 v[32:47], v[120:123], v[244:247], 0
    s_mov_b32 s74, 0
    s_nop 7
    s_nop 1
    v_max3_f32 v2, v16, v17, v18
    v_max3_f32 v2, v2, v19, v20
    v_max3_f32 v2, v2, v21, v22
    v_max3_f32 v2, v2, v23, v24
    v_max3_f32 v2, v2, v25, v26
    v_max3_f32 v2, v2, v27, v28
    v_max3_f32 v2, v2, v29, v30
    v_max_f32 v2, v2, v31
    v_max3_f32 v3, v32, v33, v34
    v_max3_f32 v3, v3, v35, v36
    v_max3_f32 v3, v3, v37, v38
    v_max3_f32 v3, v3, v39, v40
    v_max3_f32 v3, v3, v41, v42
    v_max3_f32 v3, v3, v43, v44
    v_max3_f32 v3, v3, v45, v46
    v_max_f32 v3, v3, v47
    v_mov_b32 v4, v2
    s_nop 1
    v_permlane32_swap_b32 v2, v4
    s_nop 0
    v_max_f32 v2, v2, v4
    v_mov_b32 v4, v3
    s_nop 1
    v_permlane32_swap_b32 v3, v4
    s_nop 0
    v_max_f32 v3, v3, v4
    v_sub_f32 v48, 0, v2
    v_mov_b32 v49, v48
    v_mov_b32 v50, v48
    v_mov_b32 v51, v48
    v_mov_b32 v52, v48
    v_mov_b32 v53, v48
    v_mov_b32 v54, v48
    v_mov_b32 v55, v48
    v_mov_b32 v56, v48
    v_mov_b32 v57, v48
    v_mov_b32 v58, v48
    v_mov_b32 v59, v48
    v_mov_b32 v60, v48
    v_mov_b32 v61, v48
    v_mov_b32 v62, v48
    v_mov_b32 v63, v48
    v_sub_f32 v64, 0, v3
    v_mov_b32 v65, v64
    v_mov_b32 v66, v64
    v_mov_b32 v67, v64
    v_mov_b32 v68, v64
    v_mov_b32 v69, v64
    v_mov_b32 v70, v64
    v_mov_b32 v71, v64
    v_mov_b32 v72, v64
    v_mov_b32 v73, v64
    v_mov_b32 v74, v64
    v_mov_b32 v75, v64
    v_mov_b32 v76, v64
    v_mov_b32 v77, v64
    v_mov_b32 v78, v64
    v_mov_b32 v79, v64
    s_waitcnt lgkmcnt(0)
    v_mfma_f32_32x32x16_bf16 v[16:31], v[120:123], v[240:243], v[48:63]
    s_nop 7
    s_nop 3
L3_ca:
    v_exp_f32 v16, v16
    v_exp_f32 v17, v17
    v_mfma_f32_32x32x16_bf16 v[96:111], v[140:143], v[116:119], v[96:111]
    v_exp_f32 v18, v18
    v_cvt_pk_bf16_f32 v112, v16, v17
    v_exp_f32 v19, v19
    v_exp_f32 v20, v20
    v_cvt_pk_bf16_f32 v113, v18, v19
    v_mfma_f32_32x32x16_bf16 v[32:47], v[120:123], v[244:247], v[64:79]
    ds_read_b128 v[124:127], v144 offset:1024
    ds_read_b128 v[136:139], v145 offset:1024
    ds_read_b128 v[140:143], v145 offset:1536
    v_exp_f32 v21, v21
    v_exp_f32 v22, v22
    v_cvt_pk_bf16_f32 v114, v20, v21
    v_exp_f32 v23, v23
    v_exp_f32 v24, v24
    v_cvt_pk_bf16_f32 v115, v22, v23
    v_exp_f32 v25, v25
    v_exp_f32 v26, v26
    v_mfma_f32_32x32x16_bf16 v[80:95], v[128:131], v[112:115], v[80:95]
    v_cvt_pk_bf16_f32 v116, v24, v25
    v_exp_f32 v27, v27
    v_exp_f32 v28, v28
    v_cvt_pk_bf16_f32 v117, v26, v27
    v_exp_f32 v29, v29
    v_exp_f32 v30, v30
    v_exp_f32 v31, v31
    v_cvt_pk_bf16_f32 v118, v28, v29
    v_cvt_pk_bf16_f32 v119, v30, v31
    v_exp_f32 v32, v32
    v_exp_f32 v33, v33
    v_mfma_f32_32x32x16_bf16 v[80:95], v[132:135], v[116:119], v[80:95]
    v_exp_f32 v34, v34
    v_cvt_pk_bf16_f32 v112, v32, v33
    v_exp_f32 v35, v35
    v_exp_f32 v36, v36
    v_cvt_pk_bf16_f32 v113, v34, v35
    s_waitcnt lgkmcnt(0)
    v_mfma_f32_32x32x16_bf16 v[16:31], v[124:127], v[240:243], v[48:63]
    v_exp_f32 v37, v37
    v_exp_f32 v38, v38
    v_cvt_pk_bf16_f32 v114, v36, v37
    v_exp_f32 v39, v39
    v_exp_f32 v40, v40
    v_cvt_pk_bf16_f32 v115, v38, v39
    v_exp_f32 v41, v41
    v_exp_f32 v42, v42
    v_mfma_f32_32x32x16_bf16 v[96:111], v[128:131], v[112:115], v[96:111]
    v_cvt_pk_bf16_f32 v116, v40, v41
    v_exp_f32 v43, v43
    v_exp_f32 v44, v44
    v_cvt_pk_bf16_f32 v117, v42, v43
    v_exp_f32 v45, v45
    v_exp_f32 v46, v46
    v_exp_f32 v47, v47
    v_cvt_pk_bf16_f32 v118, v44, v45
    v_cvt_pk_bf16_f32 v119, v46, v47
    v_exp_f32 v16, v16
    v_exp_f32 v17, v17
    v_mfma_f32_32x32x16_bf16 v[96:111], v[132:135], v[116:119], v[96:111]
    v_exp_f32 v18, v18
    v_cvt_pk_bf16_f32 v112, v16, v17
    v_exp_f32 v19, v19
    v_exp_f32 v20, v20
    v_cvt_pk_bf16_f32 v113, v18, v19
    v_mfma_f32_32x32x16_bf16 v[32:47], v[124:127], v[244:247], v[64:79]
    ds_read_b128 v[120:123], v144 offset:2048
    ds_read_b128 v[128:131], v145 offset:2048
    ds_read_b128 v[132:135], v145 offset:2560
    v_exp_f32 v21, v21
    v_exp_f32 v22, v22
    v_cvt_pk_bf16_f32 v114, v20, v21
    v_exp_f32 v23, v23
    v_exp_f32 v24, v24
    v_cvt_pk_bf16_f32 v115, v22, v23
    v_exp_f32 v25, v25
    v_exp_f32 v26, v26
    v_mfma_f32_32x32x16_bf16 v[80:95], v[136:139], v[112:115], v[80:95]
    v_cvt_pk_bf16_f32 v116, v24, v25
    v_exp_f32 v27, v27
    v_exp_f32 v28, v28
    v_cvt_pk_bf16_f32 v117, v26, v27
    v_exp_f32 v29, v29
    v_exp_f32 v30, v30
    v_exp_f32 v31, v31
    v_cvt_pk_bf16_f32 v118, v28, v29
    v_cvt_pk_bf16_f32 v119, v30, v31
    v_exp_f32 v32, v32
    v_exp_f32 v33, v33
    v_mfma_f32_32x32x16_bf16 v[80:95], v[140:143], v[116:119], v[80:95]
    v_exp_f32 v34, v34
    v_cvt_pk_bf16_f32 v112, v32, v33
    v_exp_f32 v35, v35
    v_exp_f32 v36, v36
    v_cvt_pk_bf16_f32 v113, v34, v35
    s_waitcnt lgkmcnt(0)
    v_mfma_f32_32x32x16_bf16 v[16:31], v[120:123], v[240:243], v[48:63]
    v_exp_f32 v37, v37
    v_exp_f32 v38, v38
    v_cvt_pk_bf16_f32 v114, v36, v37
    v_exp_f32 v39, v39
    v_exp_f32 v40, v40
    v_cvt_pk_bf16_f32 v115, v38, v39
    v_exp_f32 v41, v41
    v_exp_f32 v42, v42
    v_mfma_f32_32x32x16_bf16 v[96:111], v[136:139], v[112:115], v[96:111]
    v_cvt_pk_bf16_f32 v116, v40, v41
    v_exp_f32 v43, v43
    v_exp_f32 v44, v44
    v_cvt_pk_bf16_f32 v117, v42, v43
    v_exp_f32 v45, v45
    v_exp_f32 v46, v46
    v_exp_f32 v47, v47
    v_cvt_pk_bf16_f32 v118, v44, v45
    v_cvt_pk_bf16_f32 v119, v46, v47
    v_exp_f32 v16, v16
    v_exp_f32 v17, v17
    v_mfma_f32_32x32x16_bf16 v[96:111], v[140:143], v[116:119], v[96:111]
    v_exp_f32 v18, v18
    v_cvt_pk_bf16_f32 v112, v16, v17
    v_exp_f32 v19, v19
    v_exp_f32 v20, v20
    v_cvt_pk_bf16_f32 v113, v18, v19
    v_mfma_f32_32x32x16_bf16 v[32:47], v[120:123], v[244:247], v[64:79]
    ds_read_b128 v[124:127], v144 offset:3072
    ds_read_b128 v[136:139], v145 offset:3072
    ds_read_b128 v[140:143], v145 offset:3584
    v_exp_f32 v21, v21
    v_exp_f32 v22, v22
    v_cvt_pk_bf16_f32 v114, v20, v21
    v_exp_f32 v23, v23
    v_exp_f32 v24, v24
    v_cvt_pk_bf16_f32 v115, v22, v23
    v_exp_f32 v25, v25
    v_exp_f32 v26, v26
    v_mfma_f32_32x32x16_bf16 v[80:95], v[128:131], v[112:115], v[80:95]
    v_cvt_pk_bf16_f32 v116, v24, v25
    v_exp_f32 v27, v27
    v_exp_f32 v28, v28
    v_cvt_pk_bf16_f32 v117, v26, v27
    v_exp_f32 v29, v29
    v_exp_f32 v30, v30
    v_exp_f32 v31, v31
    v_cvt_pk_bf16_f32 v118, v28, v29
    v_cvt_pk_bf16_f32 v119, v30, v31
    v_exp_f32 v32, v32
    v_exp_f32 v33, v33
    v_mfma_f32_32x32x16_bf16 v[80:95], v[132:135], v[116:119], v[80:95]
    v_exp_f32 v34, v34
    v_cvt_pk_bf16_f32 v112, v32, v33
    v_exp_f32 v35, v35
    v_exp_f32 v36, v36
    v_cvt_pk_bf16_f32 v113, v34, v35
    s_waitcnt lgkmcnt(0)
    v_mfma_f32_32x32x16_bf16 v[16:31], v[124:127], v[240:243], v[48:63]
    v_exp_f32 v37, v37
    v_exp_f32 v38, v38
    v_cvt_pk_bf16_f32 v114, v36, v37
    v_exp_f32 v39, v39
    v_exp_f32 v40, v40
    v_cvt_pk_bf16_f32 v115, v38, v39
    v_exp_f32 v41, v41
    v_exp_f32 v42, v42
    v_mfma_f32_32x32x16_bf16 v[96:111], v[128:131], v[112:115], v[96:111]
    v_cvt_pk_bf16_f32 v116, v40, v41
    v_exp_f32 v43, v43
    v_exp_f32 v44, v44
    v_cvt_pk_bf16_f32 v117, v42, v43
    v_exp_f32 v45, v45
    v_exp_f32 v46, v46
    v_exp_f32 v47, v47
    v_cvt_pk_bf16_f32 v118, v44, v45
    v_cvt_pk_bf16_f32 v119, v46, v47
    v_exp_f32 v16, v16
    v_exp_f32 v17, v17
    v_mfma_f32_32x32x16_bf16 v[96:111], v[132:135], v[116:119], v[96:111]
    v_exp_f32 v18, v18
    v_cvt_pk_bf16_f32 v112, v16, v17
    v_exp_f32 v19, v19
    v_exp_f32 v20, v20
    v_cvt_pk_bf16_f32 v113, v18, v19
    v_mfma_f32_32x32x16_bf16 v[32:47], v[124:127], v[244:247], v[64:79]
    ds_read_b128 v[120:123], v144 offset:4096
    ds_read_b128 v[128:131], v145 offset:4096
    ds_read_b128 v[132:135], v145 offset:4608
    v_exp_f32 v21, v21
    v_exp_f32 v22, v22
    v_cvt_pk_bf16_f32 v114, v20, v21
    v_exp_f32 v23, v23
    v_exp_f32 v24, v24
    v_cvt_pk_bf16_f32 v115, v22, v23
    v_exp_f32 v25, v25
    v_exp_f32 v26, v26
    v_mfma_f32_32x32x16_bf16 v[80:95], v[136:139], v[112:115], v[80:95]
    v_cvt_pk_bf16_f32 v116, v24, v25
    v_exp_f32 v27, v27
    v_exp_f32 v28, v28
    v_cvt_pk_bf16_f32 v117, v26, v27
    v_exp_f32 v29, v29
    v_exp_f32 v30, v30
    v_exp_f32 v31, v31
    v_cvt_pk_bf16_f32 v118, v28, v29
    v_cvt_pk_bf16_f32 v119, v30, v31
    v_exp_f32 v32, v32
    v_exp_f32 v33, v33
    v_mfma_f32_32x32x16_bf16 v[80:95], v[140:143], v[116:119], v[80:95]
    v_exp_f32 v34, v34
    v_cvt_pk_bf16_f32 v112, v32, v33
    v_exp_f32 v35, v35
    v_exp_f32 v36, v36
    v_cvt_pk_bf16_f32 v113, v34, v35
    s_waitcnt lgkmcnt(0)
    v_mfma_f32_32x32x16_bf16 v[16:31], v[120:123], v[240:243], v[48:63]
    v_exp_f32 v37, v37
    v_exp_f32 v38, v38
    v_cvt_pk_bf16_f32 v114, v36, v37
    v_exp_f32 v39, v39
    v_exp_f32 v40, v40
    v_cvt_pk_bf16_f32 v115, v38, v39
    v_exp_f32 v41, v41
    v_exp_f32 v42, v42
    v_mfma_f32_32x32x16_bf16 v[96:111], v[136:139], v[112:115], v[96:111]
    v_cvt_pk_bf16_f32 v116, v40, v41
    v_exp_f32 v43, v43
    v_exp_f32 v44, v44
    v_cvt_pk_bf16_f32 v117, v42, v43
    v_exp_f32 v45, v45
    v_exp_f32 v46, v46
    v_exp_f32 v47, v47
    v_cvt_pk_bf16_f32 v118, v44, v45
    v_cvt_pk_bf16_f32 v119, v46, v47
    v_exp_f32 v16, v16
    v_exp_f32 v17, v17
    v_mfma_f32_32x32x16_bf16 v[96:111], v[140:143], v[116:119], v[96:111]
    v_exp_f32 v18, v18
    v_cvt_pk_bf16_f32 v112, v16, v17
    v_exp_f32 v19, v19
    v_exp_f32 v20, v20
    v_cvt_pk_bf16_f32 v113, v18, v19
    v_mfma_f32_32x32x16_bf16 v[32:47], v[120:123], v[244:247], v[64:79]
    ds_read_b128 v[124:127], v144 offset:5120
    ds_read_b128 v[136:139], v145 offset:5120
    ds_read_b128 v[140:143], v145 offset:5632
    v_exp_f32 v21, v21
    v_exp_f32 v22, v22
    v_cvt_pk_bf16_f32 v114, v20, v21
    v_exp_f32 v23, v23
    v_exp_f32 v24, v24
    v_cvt_pk_bf16_f32 v115, v22, v23
    v_exp_f32 v25, v25
    v_exp_f32 v26, v26
    v_mfma_f32_32x32x16_bf16 v[80:95], v[128:131], v[112:115], v[80:95]
    v_cvt_pk_bf16_f32 v116, v24, v25
    v_exp_f32 v27, v27
    v_exp_f32 v28, v28
    v_cvt_pk_bf16_f32 v117, v26, v27
    v_exp_f32 v29, v29
    v_exp_f32 v30, v30
    v_exp_f32 v31, v31
    v_cvt_pk_bf16_f32 v118, v28, v29
    v_cvt_pk_bf16_f32 v119, v30, v31
    v_exp_f32 v32, v32
    v_exp_f32 v33, v33
    v_mfma_f32_32x32x16_bf16 v[80:95], v[132:135], v[116:119], v[80:95]
    v_exp_f32 v34, v34
    v_cvt_pk_bf16_f32 v112, v32, v33
    v_exp_f32 v35, v35
    v_exp_f32 v36, v36
    v_cvt_pk_bf16_f32 v113, v34, v35
    s_waitcnt lgkmcnt(0)
    v_mfma_f32_32x32x16_bf16 v[16:31], v[124:127], v[240:243], v[48:63]
    v_exp_f32 v37, v37
    v_exp_f32 v38, v38
    v_cvt_pk_bf16_f32 v114, v36, v37
    v_exp_f32 v39, v39
    v_exp_f32 v40, v40
    v_cvt_pk_bf16_f32 v115, v38, v39
    v_exp_f32 v41, v41
    v_exp_f32 v42, v42
    v_mfma_f32_32x32x16_bf16 v[96:111], v[128:131], v[112:115], v[96:111]
    v_cvt_pk_bf16_f32 v116, v40, v41
    v_exp_f32 v43, v43
    v_exp_f32 v44, v44
    v_cvt_pk_bf16_f32 v117, v42, v43
    v_exp_f32 v45, v45
    v_exp_f32 v46, v46
    v_exp_f32 v47, v47
    v_cvt_pk_bf16_f32 v118, v44, v45
    v_cvt_pk_bf16_f32 v119, v46, v47
    v_exp_f32 v16, v16
    v_exp_f32 v17, v17
    v_mfma_f32_32x32x16_bf16 v[96:111], v[132:135], v[116:119], v[96:111]
    v_exp_f32 v18, v18
    v_cvt_pk_bf16_f32 v112, v16, v17
    v_exp_f32 v19, v19
    v_exp_f32 v20, v20
    v_cvt_pk_bf16_f32 v113, v18, v19
    v_mfma_f32_32x32x16_bf16 v[32:47], v[124:127], v[244:247], v[64:79]
    ds_read_b128 v[120:123], v144 offset:6144
    ds_read_b128 v[128:131], v145 offset:6144
    ds_read_b128 v[132:135], v145 offset:6656
    v_exp_f32 v21, v21
    v_exp_f32 v22, v22
    v_cvt_pk_bf16_f32 v114, v20, v21
    v_exp_f32 v23, v23
    v_exp_f32 v24, v24
    v_cvt_pk_bf16_f32 v115, v22, v23
    v_exp_f32 v25, v25
    v_exp_f32 v26, v26
    v_mfma_f32_32x32x16_bf16 v[80:95], v[136:139], v[112:115], v[80:95]
    v_cvt_pk_bf16_f32 v116, v24, v25
    v_exp_f32 v27, v27
    v_exp_f32 v28, v28
    v_cvt_pk_bf16_f32 v117, v26, v27
    v_exp_f32 v29, v29
    v_exp_f32 v30, v30
    v_exp_f32 v31, v31
    v_cvt_pk_bf16_f32 v118, v28, v29
    v_cvt_pk_bf16_f32 v119, v30, v31
    v_exp_f32 v32, v32
    v_exp_f32 v33, v33
    v_mfma_f32_32x32x16_bf16 v[80:95], v[140:143], v[116:119], v[80:95]
    v_exp_f32 v34, v34
    v_cvt_pk_bf16_f32 v112, v32, v33
    v_exp_f32 v35, v35
    v_exp_f32 v36, v36
    v_cvt_pk_bf16_f32 v113, v34, v35
    s_waitcnt lgkmcnt(0)
    v_mfma_f32_32x32x16_bf16 v[16:31], v[120:123], v[240:243], v[48:63]
    v_exp_f32 v37, v37
    v_exp_f32 v38, v38
    v_cvt_pk_bf16_f32 v114, v36, v37
    v_exp_f32 v39, v39
    v_exp_f32 v40, v40
    v_cvt_pk_bf16_f32 v115, v38, v39
    v_exp_f32 v41, v41
    v_exp_f32 v42, v42
    v_mfma_f32_32x32x16_bf16 v[96:111], v[136:139], v[112:115], v[96:111]
    v_cvt_pk_bf16_f32 v116, v40, v41
    v_exp_f32 v43, v43
    v_exp_f32 v44, v44
    v_cvt_pk_bf16_f32 v117, v42, v43
    v_exp_f32 v45, v45
    v_exp_f32 v46, v46
    v_exp_f32 v47, v47
    v_cvt_pk_bf16_f32 v118, v44, v45
    v_cvt_pk_bf16_f32 v119, v46, v47
    v_exp_f32 v16, v16
    v_exp_f32 v17, v17
    v_mfma_f32_32x32x16_bf16 v[96:111], v[140:143], v[116:119], v[96:111]
    v_exp_f32 v18, v18
    v_cvt_pk_bf16_f32 v112, v16, v17
    v_exp_f32 v19, v19
    v_exp_f32 v20, v20
    v_cvt_pk_bf16_f32 v113, v18, v19
    v_mfma_f32_32x32x16_bf16 v[32:47], v[120:123], v[244:247], v[64:79]
    ds_read_b128 v[124:127], v144 offset:7168
    ds_read_b128 v[136:139], v145 offset:7168
    ds_read_b128 v[140:143], v145 offset:7680
    v_exp_f32 v21, v21
    v_exp_f32 v22, v22
    v_cvt_pk_bf16_f32 v114, v20, v21
    v_exp_f32 v23, v23
    v_exp_f32 v24, v24
    v_cvt_pk_bf16_f32 v115, v22, v23
    v_exp_f32 v25, v25
    v_exp_f32 v26, v26
    v_mfma_f32_32x32x16_bf16 v[80:95], v[128:131], v[112:115], v[80:95]
    v_cvt_pk_bf16_f32 v116, v24, v25
    v_exp_f32 v27, v27
    v_exp_f32 v28, v28
    v_cvt_pk_bf16_f32 v117, v26, v27
    v_exp_f32 v29, v29
    v_exp_f32 v30, v30
    v_exp_f32 v31, v31
    v_cvt_pk_bf16_f32 v118, v28, v29
    v_cvt_pk_bf16_f32 v119, v30, v31
    v_exp_f32 v32, v32
    v_exp_f32 v33, v33
    v_mfma_f32_32x32x16_bf16 v[80:95], v[132:135], v[116:119], v[80:95]
    v_exp_f32 v34, v34
    v_cvt_pk_bf16_f32 v112, v32, v33
    v_exp_f32 v35, v35
    v_exp_f32 v36, v36
    v_cvt_pk_bf16_f32 v113, v34, v35
    s_waitcnt lgkmcnt(0)
    v_mfma_f32_32x32x16_bf16 v[16:31], v[124:127], v[240:243], v[48:63]
    v_exp_f32 v37, v37
    v_exp_f32 v38, v38
    v_cvt_pk_bf16_f32 v114, v36, v37
    v_exp_f32 v39, v39
    v_exp_f32 v40, v40
    v_cvt_pk_bf16_f32 v115, v38, v39
    v_exp_f32 v41, v41
    v_exp_f32 v42, v42
    v_mfma_f32_32x32x16_bf16 v[96:111], v[128:131], v[112:115], v[96:111]
    v_cvt_pk_bf16_f32 v116, v40, v41
    v_exp_f32 v43, v43
    v_exp_f32 v44, v44
    v_cvt_pk_bf16_f32 v117, v42, v43
    v_exp_f32 v45, v45
    v_exp_f32 v46, v46
    v_exp_f32 v47, v47
    v_cvt_pk_bf16_f32 v118, v44, v45
    v_cvt_pk_bf16_f32 v119, v46, v47
    s_barrier
    v_add_u32 v144, 16384, v144
    v_add_u32 v145, v146, v145
    v_exp_f32 v16, v16
    v_exp_f32 v17, v17
    v_mfma_f32_32x32x16_bf16 v[96:111], v[132:135], v[116:119], v[96:111]
    v_exp_f32 v18, v18
    v_cvt_pk_bf16_f32 v112, v16, v17
    v_exp_f32 v19, v19
    v_exp_f32 v20, v20
    v_cvt_pk_bf16_f32 v113, v18, v19
    v_mfma_f32_32x32x16_bf16 v[32:47], v[124:127], v[244:247], v[64:79]
    ds_read_b128 v[120:123], v144 offset:0
    ds_read_b128 v[128:131], v145 offset:0
    ds_read_b128 v[132:135], v145 offset:512
    v_exp_f32 v21, v21
    v_exp_f32 v22, v22
    v_cvt_pk_bf16_f32 v114, v20, v21
    v_exp_f32 v23, v23
    v_exp_f32 v24, v24
    v_cvt_pk_bf16_f32 v115, v22, v23
    v_exp_f32 v25, v25
    v_exp_f32 v26, v26
    v_mfma_f32_32x32x16_bf16 v[80:95], v[136:139], v[112:115], v[80:95]
    v_cvt_pk_bf16_f32 v116, v24, v25
    v_exp_f32 v27, v27
    v_exp_f32 v28, v28
    v_cvt_pk_bf16_f32 v117, v26, v27
    v_exp_f32 v29, v29
    v_exp_f32 v30, v30
    v_exp_f32 v31, v31
    v_cvt_pk_bf16_f32 v118, v28, v29
    v_cvt_pk_bf16_f32 v119, v30, v31
    v_exp_f32 v32, v32
    v_exp_f32 v33, v33
    v_mfma_f32_32x32x16_bf16 v[80:95], v[140:143], v[116:119], v[80:95]
    v_exp_f32 v34, v34
    v_cvt_pk_bf16_f32 v112, v32, v33
    v_exp_f32 v35, v35
    v_exp_f32 v36, v36
    v_cvt_pk_bf16_f32 v113, v34, v35
    s_waitcnt lgkmcnt(0)
    v_mfma_f32_32x32x16_bf16 v[16:31], v[120:123], v[240:243], v[48:63]
    v_exp_f32 v37, v37
    v_exp_f32 v38, v38
    v_cvt_pk_bf16_f32 v114, v36, v37
    v_exp_f32 v39, v39
    v_exp_f32 v40, v40
    v_cvt_pk_bf16_f32 v115, v38, v39
    v_exp_f32 v41, v41
    v_exp_f32 v42, v42
    v_mfma_f32_32x32x16_bf16 v[96:111], v[136:139], v[112:115], v[96:111]
    v_cvt_pk_bf16_f32 v116, v40, v41
    v_exp_f32 v43, v43
    v_exp_f32 v44, v44
    v_cvt_pk_bf16_f32 v117, v42, v43
    v_exp_f32 v45, v45
    v_exp_f32 v46, v46
    v_exp_f32 v47, v47
    v_cvt_pk_bf16_f32 v118, v44, v45
    v_cvt_pk_bf16_f32 v119, v46, v47
    s_add_u32 s74, s74, 1
    s_cmp_lt_u32 s74, 8
    s_cbranch_scc1 L3_ca
    s_nop 1
    v_mfma_f32_32x32x16_bf16 v[96:111], v[140:143], v[116:119], v[96:111]
    s_waitcnt lgkmcnt(0)
L3_chk:
    s_nop 7
    s_nop 3
    v_mov_b32 v2, v88
    v_mov_b32 v3, v104
    s_nop 1
    v_permlane32_swap_b32 v88, v2
    v_permlane32_swap_b32 v104, v3
    s_nop 0
    v_mov_b32 v4, 0x5d800000
    v_cmp_nle_f32 vcc, v88, v4
    s_mov_b64 s[80:81], vcc
    v_cmp_nle_f32 vcc, v104, v4
    s_or_b64 vcc, vcc, s[80:81]
    s_cmp_lg_u32 s47, 0
    s_cbranch_scc1 L3_ok
    s_cbranch_vccz L3_ok
    s_mov_b32 s47, 1
    v_mov_b32 v2, 0xff800000
    v_mov_b32 v3, 0xff800000
    v_mov_b32 v6, v252
    v_lshlrev_b32 v7, 3, v146
    v_sub_u32 v7, v145, v7
    s_mov_b32 s74, 0
L3_re0:
    ds_read_b128 v[120:123], v6 offset:0
    s_waitcnt lgkmcnt(0)
    v_mfma_f32_32x32x16_bf16 v[16:31], v[120:123], v[240:243], 0
    v_mfma_f32_32x32x16_bf16 v[32:47], v[120:123], v[244:247], 0
    s_nop 7
    s_nop 3
    v_max3_f32 v2, v2, v16, v17
    v_max3_f32 v2, v2, v18, v19
    v_max3_f32 v2, v2, v20, v21
    v_max3_f32 v2, v2, v22, v23
    v_max3_f32 v2, v2, v24, v25
    v_max3_f32 v2, v2, v26, v27
    v_max3_f32 v2, v2, v28, v29
    v_max3_f32 v2, v2, v30, v31
    v_max3_f32 v3, v3, v32, v33
    v_max3_f32 v3, v3, v34, v35
    v_max3_f32 v3, v3, v36, v37
    v_max3_f32 v3, v3, v38, v39
    v_max3_f32 v3, v3, v40, v41
    v_max3_f32 v3, v3, v42, v43
    v_max3_f32 v3, v3, v44, v45
    v_max3_f32 v3, v3, v46, v47
    ds_read_b128 v[120:123], v6 offset:1024
    s_waitcnt lgkmcnt(0)
    v_mfma_f32_32x32x16_bf16 v[16:31], v[120:123], v[240:243], 0
    v_mfma_f32_32x32x16_bf16 v[32:47], v[120:123], v[244:247], 0
    s_nop 7
    s_nop 3
    v_max3_f32 v2, v2, v16, v17
    v_max3_f32 v2, v2, v18, v19
    v_max3_f32 v2, v2, v20, v21
    v_max3_f32 v2, v2, v22, v23
    v_max3_f32 v2, v2, v24, v25
    v_max3_f32 v2, v2, v26, v27
    v_max3_f32 v2, v2, v28, v29
    v_max3_f32 v2, v2, v30, v31
    v_max3_f32 v3, v3, v32, v33
    v_max3_f32 v3, v3, v34, v35
    v_max3_f32 v3, v3, v36, v37
    v_max3_f32 v3, v3, v38, v39
    v_max3_f32 v3, v3, v40, v41
    v_max3_f32 v3, v3, v42, v43
    v_max3_f32 v3, v3, v44, v45
    v_max3_f32 v3, v3, v46, v47
    ds_read_b128 v[120:123], v6 offset:2048
    s_waitcnt lgkmcnt(0)
    v_mfma_f32_32x32x16_bf16 v[16:31], v[120:123], v[240:243], 0
    v_mfma_f32_32x32x16_bf16 v[32:47], v[120:123], v[244:247], 0
    s_nop 7
    s_nop 3
    v_max3_f32 v2, v2, v16, v17
    v_max3_f32 v2, v2, v18, v19
    v_max3_f32 v2, v2, v20, v21
    v_max3_f32 v2, v2, v22, v23
    v_max3_f32 v2, v2, v24, v25
    v_max3_f32 v2, v2, v26, v27
    v_max3_f32 v2, v2, v28, v29
    v_max3_f32 v2, v2, v30, v31
    v_max3_f32 v3, v3, v32, v33
    v_max3_f32 v3, v3, v34, v35
    v_max3_f32 v3, v3, v36, v37
    v_max3_f32 v3, v3, v38, v39
    v_max3_f32 v3, v3, v40, v41
    v_max3_f32 v3, v3, v42, v43
    v_max3_f32 v3, v3, v44, v45
    v_max3_f32 v3, v3, v46, v47
    ds_read_b128 v[120:123], v6 offset:3072
    s_waitcnt lgkmcnt(0)
    v_mfma_f32_32x32x16_bf16 v[16:31], v[120:123], v[240:243], 0
    v_mfma_f32_32x32x16_bf16 v[32:47], v[120:123], v[244:247], 0
    s_nop 7
    s_nop 3
    v_max3_f32 v2, v2, v16, v17
    v_max3_f32 v2, v2, v18, v19
    v_max3_f32 v2, v2, v20, v21
    v_max3_f32 v2, v2, v22, v23
    v_max3_f32 v2, v2, v24, v25
    v_max3_f32 v2, v2, v26, v27
    v_max3_f32 v2, v2, v28, v29
    v_max3_f32 v2, v2, v30, v31
    v_max3_f32 v3, v3, v32, v33
    v_max3_f32 v3, v3, v34, v35
    v_max3_f32 v3, v3, v36, v37
    v_max3_f32 v3, v3, v38, v39
    v_max3_f32 v3, v3, v40, v41
    v_max3_f32 v3, v3, v42, v43
    v_max3_f32 v3, v3, v44, v45
    v_max3_f32 v3, v3, v46, v47
    ds_read_b128 v[120:123], v6 offset:4096
    s_waitcnt lgkmcnt(0)
    v_mfma_f32_32x32x16_bf16 v[16:31], v[120:123], v[240:243], 0
    v_mfma_f32_32x32x16_bf16 v[32:47], v[120:123], v[244:247], 0
    s_nop 7
    s_nop 3
    v_max3_f32 v2, v2, v16, v17
    v_max3_f32 v2, v2, v18, v19
    v_max3_f32 v2, v2, v20, v21
    v_max3_f32 v2, v2, v22, v23
    v_max3_f32 v2, v2, v24, v25
    v_max3_f32 v2, v2, v26, v27
    v_max3_f32 v2, v2, v28, v29
    v_max3_f32 v2, v2, v30, v31
    v_max3_f32 v3, v3, v32, v33
    v_max3_f32 v3, v3, v34, v35
    v_max3_f32 v3, v3, v36, v37
    v_max3_f32 v3, v3, v38, v39
    v_max3_f32 v3, v3, v40, v41
    v_max3_f32 v3, v3, v42, v43
    v_max3_f32 v3, v3, v44, v45
    v_max3_f32 v3, v3, v46, v47
    ds_read_b128 v[120:123], v6 offset:5120
    s_waitcnt lgkmcnt(0)
    v_mfma_f32_32x32x16_bf16 v[16:31], v[120:123], v[240:243], 0
    v_mfma_f32_32x32x16_bf16 v[32:47], v[120:123], v[244:247], 0
    s_nop 7
    s_nop 3
    v_max3_f32 v2, v2, v16, v17
    v_max3_f32 v2, v2, v18, v19
    v_max3_f32 v2, v2, v20, v21
    v_max3_f32 v2, v2, v22, v23
    v_max3_f32 v2, v2, v24, v25
    v_max3_f32 v2, v2, v26, v27
    v_max3_f32 v2, v2, v28, v29
    v_max3_f32 v2, v2, v30, v31
    v_max3_f32 v3, v3, v32, v33
    v_max3_f32 v3, v3, v34, v35
    v_max3_f32 v3, v3, v36, v37
    v_max3_f32 v3, v3, v38, v39
    v_max3_f32 v3, v3, v40, v41
    v_max3_f32 v3, v3, v42, v43
    v_max3_f32 v3, v3, v44, v45
    v_max3_f32 v3, v3, v46, v47
    ds_read_b128 v[120:123], v6 offset:6144
    s_waitcnt lgkmcnt(0)
    v_mfma_f32_32x32x16_bf16 v[16:31], v[120:123], v[240:243], 0
    v_mfma_f32_32x32x16_bf16 v[32:47], v[120:123], v[244:247], 0
    s_nop 7
    s_nop 3
    v_max3_f32 v2, v2, v16, v17
    v_max3_f32 v2, v2, v18, v19
    v_max3_f32 v2, v2, v20, v21
    v_max3_f32 v2, v2, v22, v23
    v_max3_f32 v2, v2, v24, v25
    v_max3_f32 v2, v2, v26, v27
    v_max3_f32 v2, v2, v28, v29
    v_max3_f32 v2, v2, v30, v31
    v_max3_f32 v3, v3, v32, v33
    v_max3_f32 v3, v3, v34, v35
    v_max3_f32 v3, v3, v36, v37
    v_max3_f32 v3, v3, v38, v39
    v_max3_f32 v3, v3, v40, v41
    v_max3_f32 v3, v3, v42, v43
    v_max3_f32 v3, v3, v44, v45
    v_max3_f32 v3, v3, v46, v47
    ds_read_b128 v[120:123], v6 offset:7168
    s_waitcnt lgkmcnt(0)
    v_mfma_f32_32x32x16_bf16 v[16:31], v[120:123], v[240:243], 0
    v_mfma_f32_32x32x16_bf16 v[32:47], v[120:123], v[244:247], 0
    s_nop 7
    s_nop 3
    v_max3_f32 v2, v2, v16, v17
    v_max3_f32 v2, v2, v18, v19
    v_max3_f32 v2, v2, v20, v21
    v_max3_f32 v2, v2, v22, v23
    v_max3_f32 v2, v2, v24, v25
    v_max3_f32 v2, v2, v26, v27
    v_max3_f32 v2, v2, v28, v29
    v_max3_f32 v2, v2, v30, v31
    v_max3_f32 v3, v3, v32, v33
    v_max3_f32 v3, v3, v34, v35
    v_max3_f32 v3, v3, v36, v37
    v_max3_f32 v3, v3, v38, v39
    v_max3_f32 v3, v3, v40, v41
    v_max3_f32 v3, v3, v42, v43
    v_max3_f32 v3, v3, v44, v45
    v_max3_f32 v3, v3, v46, v47
    v_add_u32 v6, 16384, v6
    v_add_u32 v7, v146, v7
    s_add_u32 s74, s74, 1
    s_cmp_lt_u32 s74, 8
    s_cbranch_scc1 L3_re0
    v_mov_b32 v4, v2
    s_nop 1
    v_permlane32_swap_b32 v2, v4
    s_nop 0
    v_max_f32 v2, v2, v4
    v_mov_b32 v4, v3
    s_nop 1
    v_permlane32_swap_b32 v3, v4
    s_nop 0
    v_max_f32 v3, v3, v4
    v_sub_f32 v48, 0, v2
    v_mov_b32 v49, v48
    v_mov_b32 v50, v48
    v_mov_b32 v51, v48
    v_mov_b32 v52, v48
    v_mov_b32 v53, v48
    v_mov_b32 v54, v48
    v_mov_b32 v55, v48
    v_mov_b32 v56, v48
    v_mov_b32 v57, v48
    v_mov_b32 v58, v48
    v_mov_b32 v59, v48
    v_mov_b32 v60, v48
    v_mov_b32 v61, v48
    v_mov_b32 v62, v48
    v_mov_b32 v63, v48
    v_mov_b32 v80, 0
    v_mov_b32 v81, 0
    v_mov_b32 v82, 0
    v_mov_b32 v83, 0
    v_mov_b32 v84, 0
    v_mov_b32 v85, 0
    v_mov_b32 v86, 0
    v_mov_b32 v87, 0
    v_mov_b32 v88, 0
    v_mov_b32 v89, 0
    v_mov_b32 v90, 0
    v_mov_b32 v91, 0
    v_mov_b32 v92, 0
    v_mov_b32 v93, 0
    v_mov_b32 v94, 0
    v_mov_b32 v95, 0
    v_sub_f32 v64, 0, v3
    v_mov_b32 v65, v64
    v_mov_b32 v66, v64
    v_mov_b32 v67, v64
    v_mov_b32 v68, v64
    v_mov_b32 v69, v64
    v_mov_b32 v70, v64
    v_mov_b32 v71, v64
    v_mov_b32 v72, v64
    v_mov_b32 v73, v64
    v_mov_b32 v74, v64
    v_mov_b32 v75, v64
    v_mov_b32 v76, v64
    v_mov_b32 v77, v64
    v_mov_b32 v78, v64
    v_mov_b32 v79, v64
    v_mov_b32 v96, 0
    v_mov_b32 v97, 0
    v_mov_b32 v98, 0
    v_mov_b32 v99, 0
    v_mov_b32 v100, 0
    v_mov_b32 v101, 0
    v_mov_b32 v102, 0
    v_mov_b32 v103, 0
    v_mov_b32 v104, 0
    v_mov_b32 v105, 0
    v_mov_b32 v106, 0
    v_mov_b32 v107, 0
    v_mov_b32 v108, 0
    v_mov_b32 v109, 0
    v_mov_b32 v110, 0
    v_mov_b32 v111, 0
    v_mov_b32 v6, v252
    v_lshlrev_b32 v7, 3, v146
    v_sub_u32 v7, v145, v7
    s_mov_b32 s74, 0
L3_re1:
    ds_read_b128 v[120:123], v6 offset:0
    ds_read_b128 v[128:131], v7 offset:0
    ds_read_b128 v[132:135], v7 offset:512
    s_waitcnt lgkmcnt(0)
    v_mfma_f32_32x32x16_bf16 v[16:31], v[120:123], v[240:243], v[48:63]
    v_mfma_f32_32x32x16_bf16 v[32:47], v[120:123], v[244:247], v[64:79]
    s_nop 7
    s_nop 3
    v_exp_f32 v16, v16
    v_exp_f32 v17, v17
    v_exp_f32 v18, v18
    v_exp_f32 v19, v19
    v_exp_f32 v20, v20
    v_exp_f32 v21, v21
    v_exp_f32 v22, v22
    v_exp_f32 v23, v23
    v_exp_f32 v24, v24
    v_exp_f32 v25, v25
    v_exp_f32 v26, v26
    v_exp_f32 v27, v27
    v_exp_f32 v28, v28
    v_exp_f32 v29, v29
    v_exp_f32 v30, v30
    v_exp_f32 v31, v31
    s_nop 0
    v_cvt_pk_bf16_f32 v112, v16, v17
    v_cvt_pk_bf16_f32 v113, v18, v19
    v_cvt_pk_bf16_f32 v114, v20, v21
    v_cvt_pk_bf16_f32 v115, v22, v23
    v_cvt_pk_bf16_f32 v116, v24, v25
    v_cvt_pk_bf16_f32 v117, v26, v27
    v_cvt_pk_bf16_f32 v118, v28, v29
    v_cvt_pk_bf16_f32 v119, v30, v31
    s_nop 1
    v_mfma_f32_32x32x16_bf16 v[80:95], v[128:131], v[112:115], v[80:95]
    v_mfma_f32_32x32x16_bf16 v[80:95], v[132:135], v[116:119], v[80:95]
    v_exp_f32 v32, v32
    v_exp_f32 v33, v33
    v_exp_f32 v34, v34
    v_exp_f32 v35, v35
    v_exp_f32 v36, v36
    v_exp_f32 v37, v37
    v_exp_f32 v38, v38
    v_exp_f32 v39, v39
    v_exp_f32 v40, v40
    v_exp_f32 v41, v41
    v_exp_f32 v42, v42
    v_exp_f32 v43, v43
    v_exp_f32 v44, v44
    v_exp_f32 v45, v45
    v_exp_f32 v46, v46
    v_exp_f32 v47, v47
    s_nop 0
    v_cvt_pk_bf16_f32 v112, v32, v33
    v_cvt_pk_bf16_f32 v113, v34, v35
    v_cvt_pk_bf16_f32 v114, v36, v37
    v_cvt_pk_bf16_f32 v115, v38, v39
    v_cvt_pk_bf16_f32 v116, v40, v41
    v_cvt_pk_bf16_f32 v117, v42, v43
    v_cvt_pk_bf16_f32 v118, v44, v45
    v_cvt_pk_bf16_f32 v119, v46, v47
    s_nop 1
    v_mfma_f32_32x32x16_bf16 v[96:111], v[128:131], v[112:115], v[96:111]
    v_mfma_f32_32x32x16_bf16 v[96:111], v[132:135], v[116:119], v[96:111]
    ds_read_b128 v[120:123], v6 offset:1024
    ds_read_b128 v[128:131], v7 offset:1024
    ds_read_b128 v[132:135], v7 offset:1536
    s_waitcnt lgkmcnt(0)
    v_mfma_f32_32x32x16_bf16 v[16:31], v[120:123], v[240:243], v[48:63]
    v_mfma_f32_32x32x16_bf16 v[32:47], v[120:123], v[244:247], v[64:79]
    s_nop 7
    s_nop 3
    v_exp_f32 v16, v16
    v_exp_f32 v17, v17
    v_exp_f32 v18, v18
    v_exp_f32 v19, v19
    v_exp_f32 v20, v20
    v_exp_f32 v21, v21
    v_exp_f32 v22, v22
    v_exp_f32 v23, v23
    v_exp_f32 v24, v24
    v_exp_f32 v25, v25
    v_exp_f32 v26, v26
    v_exp_f32 v27, v27
    v_exp_f32 v28, v28
    v_exp_f32 v29, v29
    v_exp_f32 v30, v30
    v_exp_f32 v31, v31
    s_nop 0
    v_cvt_pk_bf16_f32 v112, v16, v17
    v_cvt_pk_bf16_f32 v113, v18, v19
    v_cvt_pk_bf16_f32 v114, v20, v21
    v_cvt_pk_bf16_f32 v115, v22, v23
    v_cvt_pk_bf16_f32 v116, v24, v25
    v_cvt_pk_bf16_f32 v117, v26, v27
    v_cvt_pk_bf16_f32 v118, v28, v29
    v_cvt_pk_bf16_f32 v119, v30, v31
    s_nop 1
    v_mfma_f32_32x32x16_bf16 v[80:95], v[128:131], v[112:115], v[80:95]
    v_mfma_f32_32x32x16_bf16 v[80:95], v[132:135], v[116:119], v[80:95]
    v_exp_f32 v32, v32
    v_exp_f32 v33, v33
    v_exp_f32 v34, v34
    v_exp_f32 v35, v35
    v_exp_f32 v36, v36
    v_exp_f32 v37, v37
    v_exp_f32 v38, v38
    v_exp_f32 v39, v39
    v_exp_f32 v40, v40
    v_exp_f32 v41, v41
    v_exp_f32 v42, v42
    v_exp_f32 v43, v43
    v_exp_f32 v44, v44
    v_exp_f32 v45, v45
    v_exp_f32 v46, v46
    v_exp_f32 v47, v47
    s_nop 0
    v_cvt_pk_bf16_f32 v112, v32, v33
    v_cvt_pk_bf16_f32 v113, v34, v35
    v_cvt_pk_bf16_f32 v114, v36, v37
    v_cvt_pk_bf16_f32 v115, v38, v39
    v_cvt_pk_bf16_f32 v116, v40, v41
    v_cvt_pk_bf16_f32 v117, v42, v43
    v_cvt_pk_bf16_f32 v118, v44, v45
    v_cvt_pk_bf16_f32 v119, v46, v47
    s_nop 1
    v_mfma_f32_32x32x16_bf16 v[96:111], v[128:131], v[112:115], v[96:111]
    v_mfma_f32_32x32x16_bf16 v[96:111], v[132:135], v[116:119], v[96:111]
    ds_read_b128 v[120:123], v6 offset:2048
    ds_read_b128 v[128:131], v7 offset:2048
    ds_read_b128 v[132:135], v7 offset:2560
    s_waitcnt lgkmcnt(0)
    v_mfma_f32_32x32x16_bf16 v[16:31], v[120:123], v[240:243], v[48:63]
    v_mfma_f32_32x32x16_bf16 v[32:47], v[120:123], v[244:247], v[64:79]
    s_nop 7
    s_nop 3
    v_exp_f32 v16, v16
    v_exp_f32 v17, v17
    v_exp_f32 v18, v18
    v_exp_f32 v19, v19
    v_exp_f32 v20, v20
    v_exp_f32 v21, v21
    v_exp_f32 v22, v22
    v_exp_f32 v23, v23
    v_exp_f32 v24, v24
    v_exp_f32 v25, v25
    v_exp_f32 v26, v26
    v_exp_f32 v27, v27
    v_exp_f32 v28, v28
    v_exp_f32 v29, v29
    v_exp_f32 v30, v30
    v_exp_f32 v31, v31
    s_nop 0
    v_cvt_pk_bf16_f32 v112, v16, v17
    v_cvt_pk_bf16_f32 v113, v18, v19
    v_cvt_pk_bf16_f32 v114, v20, v21
    v_cvt_pk_bf16_f32 v115, v22, v23
    v_cvt_pk_bf16_f32 v116, v24, v25
    v_cvt_pk_bf16_f32 v117, v26, v27
    v_cvt_pk_bf16_f32 v118, v28, v29
    v_cvt_pk_bf16_f32 v119, v30, v31
    s_nop 1
    v_mfma_f32_32x32x16_bf16 v[80:95], v[128:131], v[112:115], v[80:95]
    v_mfma_f32_32x32x16_bf16 v[80:95], v[132:135], v[116:119], v[80:95]
    v_exp_f32 v32, v32
    v_exp_f32 v33, v33
    v_exp_f32 v34, v34
    v_exp_f32 v35, v35
    v_exp_f32 v36, v36
    v_exp_f32 v37, v37
    v_exp_f32 v38, v38
    v_exp_f32 v39, v39
    v_exp_f32 v40, v40
    v_exp_f32 v41, v41
    v_exp_f32 v42, v42
    v_exp_f32 v43, v43
    v_exp_f32 v44, v44
    v_exp_f32 v45, v45
    v_exp_f32 v46, v46
    v_exp_f32 v47, v47
    s_nop 0
    v_cvt_pk_bf16_f32 v112, v32, v33
    v_cvt_pk_bf16_f32 v113, v34, v35
    v_cvt_pk_bf16_f32 v114, v36, v37
    v_cvt_pk_bf16_f32 v115, v38, v39
    v_cvt_pk_bf16_f32 v116, v40, v41
    v_cvt_pk_bf16_f32 v117, v42, v43
    v_cvt_pk_bf16_f32 v118, v44, v45
    v_cvt_pk_bf16_f32 v119, v46, v47
    s_nop 1
    v_mfma_f32_32x32x16_bf16 v[96:111], v[128:131], v[112:115], v[96:111]
    v_mfma_f32_32x32x16_bf16 v[96:111], v[132:135], v[116:119], v[96:111]
    ds_read_b128 v[120:123], v6 offset:3072
    ds_read_b128 v[128:131], v7 offset:3072
    ds_read_b128 v[132:135], v7 offset:3584
    s_waitcnt lgkmcnt(0)
    v_mfma_f32_32x32x16_bf16 v[16:31], v[120:123], v[240:243], v[48:63]
    v_mfma_f32_32x32x16_bf16 v[32:47], v[120:123], v[244:247], v[64:79]
    s_nop 7
    s_nop 3
    v_exp_f32 v16, v16
    v_exp_f32 v17, v17
    v_exp_f32 v18, v18
    v_exp_f32 v19, v19
    v_exp_f32 v20, v20
    v_exp_f32 v21, v21
    v_exp_f32 v22, v22
    v_exp_f32 v23, v23
    v_exp_f32 v24, v24
    v_exp_f32 v25, v25
    v_exp_f32 v26, v26
    v_exp_f32 v27, v27
    v_exp_f32 v28, v28
    v_exp_f32 v29, v29
    v_exp_f32 v30, v30
    v_exp_f32 v31, v31
    s_nop 0
    v_cvt_pk_bf16_f32 v112, v16, v17
    v_cvt_pk_bf16_f32 v113, v18, v19
    v_cvt_pk_bf16_f32 v114, v20, v21
    v_cvt_pk_bf16_f32 v115, v22, v23
    v_cvt_pk_bf16_f32 v116, v24, v25
    v_cvt_pk_bf16_f32 v117, v26, v27
    v_cvt_pk_bf16_f32 v118, v28, v29
    v_cvt_pk_bf16_f32 v119, v30, v31
    s_nop 1
    v_mfma_f32_32x32x16_bf16 v[80:95], v[128:131], v[112:115], v[80:95]
    v_mfma_f32_32x32x16_bf16 v[80:95], v[132:135], v[116:119], v[80:95]
    v_exp_f32 v32, v32
    v_exp_f32 v33, v33
    v_exp_f32 v34, v34
    v_exp_f32 v35, v35
    v_exp_f32 v36, v36
    v_exp_f32 v37, v37
    v_exp_f32 v38, v38
    v_exp_f32 v39, v39
    v_exp_f32 v40, v40
    v_exp_f32 v41, v41
    v_exp_f32 v42, v42
    v_exp_f32 v43, v43
    v_exp_f32 v44, v44
    v_exp_f32 v45, v45
    v_exp_f32 v46, v46
    v_exp_f32 v47, v47
    s_nop 0
    v_cvt_pk_bf16_f32 v112, v32, v33
    v_cvt_pk_bf16_f32 v113, v34, v35
    v_cvt_pk_bf16_f32 v114, v36, v37
    v_cvt_pk_bf16_f32 v115, v38, v39
    v_cvt_pk_bf16_f32 v116, v40, v41
    v_cvt_pk_bf16_f32 v117, v42, v43
    v_cvt_pk_bf16_f32 v118, v44, v45
    v_cvt_pk_bf16_f32 v119, v46, v47
    s_nop 1
    v_mfma_f32_32x32x16_bf16 v[96:111], v[128:131], v[112:115], v[96:111]
    v_mfma_f32_32x32x16_bf16 v[96:111], v[132:135], v[116:119], v[96:111]
    ds_read_b128 v[120:123], v6 offset:4096
    ds_read_b128 v[128:131], v7 offset:4096
    ds_read_b128 v[132:135], v7 offset:4608
    s_waitcnt lgkmcnt(0)
    v_mfma_f32_32x32x16_bf16 v[16:31], v[120:123], v[240:243], v[48:63]
    v_mfma_f32_32x32x16_bf16 v[32:47], v[120:123], v[244:247], v[64:79]
    s_nop 7
    s_nop 3
    v_exp_f32 v16, v16
    v_exp_f32 v17, v17
    v_exp_f32 v18, v18
    v_exp_f32 v19, v19
    v_exp_f32 v20, v20
    v_exp_f32 v21, v21
    v_exp_f32 v22, v22
    v_exp_f32 v23, v23
    v_exp_f32 v24, v24
    v_exp_f32 v25, v25
    v_exp_f32 v26, v26
    v_exp_f32 v27, v27
    v_exp_f32 v28, v28
    v_exp_f32 v29, v29
    v_exp_f32 v30, v30
    v_exp_f32 v31, v31
    s_nop 0
    v_cvt_pk_bf16_f32 v112, v16, v17
    v_cvt_pk_bf16_f32 v113, v18, v19
    v_cvt_pk_bf16_f32 v114, v20, v21
    v_cvt_pk_bf16_f32 v115, v22, v23
    v_cvt_pk_bf16_f32 v116, v24, v25
    v_cvt_pk_bf16_f32 v117, v26, v27
    v_cvt_pk_bf16_f32 v118, v28, v29
    v_cvt_pk_bf16_f32 v119, v30, v31
    s_nop 1
    v_mfma_f32_32x32x16_bf16 v[80:95], v[128:131], v[112:115], v[80:95]
    v_mfma_f32_32x32x16_bf16 v[80:95], v[132:135], v[116:119], v[80:95]
    v_exp_f32 v32, v32
    v_exp_f32 v33, v33
    v_exp_f32 v34, v34
    v_exp_f32 v35, v35
    v_exp_f32 v36, v36
    v_exp_f32 v37, v37
    v_exp_f32 v38, v38
    v_exp_f32 v39, v39
    v_exp_f32 v40, v40
    v_exp_f32 v41, v41
    v_exp_f32 v42, v42
    v_exp_f32 v43, v43
    v_exp_f32 v44, v44
    v_exp_f32 v45, v45
    v_exp_f32 v46, v46
    v_exp_f32 v47, v47
    s_nop 0
    v_cvt_pk_bf16_f32 v112, v32, v33
    v_cvt_pk_bf16_f32 v113, v34, v35
    v_cvt_pk_bf16_f32 v114, v36, v37
    v_cvt_pk_bf16_f32 v115, v38, v39
    v_cvt_pk_bf16_f32 v116, v40, v41
    v_cvt_pk_bf16_f32 v117, v42, v43
    v_cvt_pk_bf16_f32 v118, v44, v45
    v_cvt_pk_bf16_f32 v119, v46, v47
    s_nop 1
    v_mfma_f32_32x32x16_bf16 v[96:111], v[128:131], v[112:115], v[96:111]
    v_mfma_f32_32x32x16_bf16 v[96:111], v[132:135], v[116:119], v[96:111]
    ds_read_b128 v[120:123], v6 offset:5120
    ds_read_b128 v[128:131], v7 offset:5120
    ds_read_b128 v[132:135], v7 offset:5632
    s_waitcnt lgkmcnt(0)
    v_mfma_f32_32x32x16_bf16 v[16:31], v[120:123], v[240:243], v[48:63]
    v_mfma_f32_32x32x16_bf16 v[32:47], v[120:123], v[244:247], v[64:79]
    s_nop 7
    s_nop 3
    v_exp_f32 v16, v16
    v_exp_f32 v17, v17
    v_exp_f32 v18, v18
    v_exp_f32 v19, v19
    v_exp_f32 v20, v20
    v_exp_f32 v21, v21
    v_exp_f32 v22, v22
    v_exp_f32 v23, v23
    v_exp_f32 v24, v24
    v_exp_f32 v25, v25
    v_exp_f32 v26, v26
    v_exp_f32 v27, v27
    v_exp_f32 v28, v28
    v_exp_f32 v29, v29
    v_exp_f32 v30, v30
    v_exp_f32 v31, v31
    s_nop 0
    v_cvt_pk_bf16_f32 v112, v16, v17
    v_cvt_pk_bf16_f32 v113, v18, v19
    v_cvt_pk_bf16_f32 v114, v20, v21
    v_cvt_pk_bf16_f32 v115, v22, v23
    v_cvt_pk_bf16_f32 v116, v24, v25
    v_cvt_pk_bf16_f32 v117, v26, v27
    v_cvt_pk_bf16_f32 v118, v28, v29
    v_cvt_pk_bf16_f32 v119, v30, v31
    s_nop 1
    v_mfma_f32_32x32x16_bf16 v[80:95], v[128:131], v[112:115], v[80:95]
    v_mfma_f32_32x32x16_bf16 v[80:95], v[132:135], v[116:119], v[80:95]
    v_exp_f32 v32, v32
    v_exp_f32 v33, v33
    v_exp_f32 v34, v34
    v_exp_f32 v35, v35
    v_exp_f32 v36, v36
    v_exp_f32 v37, v37
    v_exp_f32 v38, v38
    v_exp_f32 v39, v39
    v_exp_f32 v40, v40
    v_exp_f32 v41, v41
    v_exp_f32 v42, v42
    v_exp_f32 v43, v43
    v_exp_f32 v44, v44
    v_exp_f32 v45, v45
    v_exp_f32 v46, v46
    v_exp_f32 v47, v47
    s_nop 0
    v_cvt_pk_bf16_f32 v112, v32, v33
    v_cvt_pk_bf16_f32 v113, v34, v35
    v_cvt_pk_bf16_f32 v114, v36, v37
    v_cvt_pk_bf16_f32 v115, v38, v39
    v_cvt_pk_bf16_f32 v116, v40, v41
    v_cvt_pk_bf16_f32 v117, v42, v43
    v_cvt_pk_bf16_f32 v118, v44, v45
    v_cvt_pk_bf16_f32 v119, v46, v47
    s_nop 1
    v_mfma_f32_32x32x16_bf16 v[96:111], v[128:131], v[112:115], v[96:111]
    v_mfma_f32_32x32x16_bf16 v[96:111], v[132:135], v[116:119], v[96:111]
    ds_read_b128 v[120:123], v6 offset:6144
    ds_read_b128 v[128:131], v7 offset:6144
    ds_read_b128 v[132:135], v7 offset:6656
    s_waitcnt lgkmcnt(0)
    v_mfma_f32_32x32x16_bf16 v[16:31], v[120:123], v[240:243], v[48:63]
    v_mfma_f32_32x32x16_bf16 v[32:47], v[120:123], v[244:247], v[64:79]
    s_nop 7
    s_nop 3
    v_exp_f32 v16, v16
    v_exp_f32 v17, v17
    v_exp_f32 v18, v18
    v_exp_f32 v19, v19
    v_exp_f32 v20, v20
    v_exp_f32 v21, v21
    v_exp_f32 v22, v22
    v_exp_f32 v23, v23
    v_exp_f32 v24, v24
    v_exp_f32 v25, v25
    v_exp_f32 v26, v26
    v_exp_f32 v27, v27
    v_exp_f32 v28, v28
    v_exp_f32 v29, v29
    v_exp_f32 v30, v30
    v_exp_f32 v31, v31
    s_nop 0
    v_cvt_pk_bf16_f32 v112, v16, v17
    v_cvt_pk_bf16_f32 v113, v18, v19
    v_cvt_pk_bf16_f32 v114, v20, v21
    v_cvt_pk_bf16_f32 v115, v22, v23
    v_cvt_pk_bf16_f32 v116, v24, v25
    v_cvt_pk_bf16_f32 v117, v26, v27
    v_cvt_pk_bf16_f32 v118, v28, v29
    v_cvt_pk_bf16_f32 v119, v30, v31
    s_nop 1
    v_mfma_f32_32x32x16_bf16 v[80:95], v[128:131], v[112:115], v[80:95]
    v_mfma_f32_32x32x16_bf16 v[80:95], v[132:135], v[116:119], v[80:95]
    v_exp_f32 v32, v32
    v_exp_f32 v33, v33
    v_exp_f32 v34, v34
    v_exp_f32 v35, v35
    v_exp_f32 v36, v36
    v_exp_f32 v37, v37
    v_exp_f32 v38, v38
    v_exp_f32 v39, v39
    v_exp_f32 v40, v40
    v_exp_f32 v41, v41
    v_exp_f32 v42, v42
    v_exp_f32 v43, v43
    v_exp_f32 v44, v44
    v_exp_f32 v45, v45
    v_exp_f32 v46, v46
    v_exp_f32 v47, v47
    s_nop 0
    v_cvt_pk_bf16_f32 v112, v32, v33
    v_cvt_pk_bf16_f32 v113, v34, v35
    v_cvt_pk_bf16_f32 v114, v36, v37
    v_cvt_pk_bf16_f32 v115, v38, v39
    v_cvt_pk_bf16_f32 v116, v40, v41
    v_cvt_pk_bf16_f32 v117, v42, v43
    v_cvt_pk_bf16_f32 v118, v44, v45
    v_cvt_pk_bf16_f32 v119, v46, v47
    s_nop 1
    v_mfma_f32_32x32x16_bf16 v[96:111], v[128:131], v[112:115], v[96:111]
    v_mfma_f32_32x32x16_bf16 v[96:111], v[132:135], v[116:119], v[96:111]
    ds_read_b128 v[120:123], v6 offset:7168
    ds_read_b128 v[128:131], v7 offset:7168
    ds_read_b128 v[132:135], v7 offset:7680
    s_waitcnt lgkmcnt(0)
    v_mfma_f32_32x32x16_bf16 v[16:31], v[120:123], v[240:243], v[48:63]
    v_mfma_f32_32x32x16_bf16 v[32:47], v[120:123], v[244:247], v[64:79]
    s_nop 7
    s_nop 3
    v_exp_f32 v16, v16
    v_exp_f32 v17, v17
    v_exp_f32 v18, v18
    v_exp_f32 v19, v19
    v_exp_f32 v20, v20
    v_exp_f32 v21, v21
    v_exp_f32 v22, v22
    v_exp_f32 v23, v23
    v_exp_f32 v24, v24
    v_exp_f32 v25, v25
    v_exp_f32 v26, v26
    v_exp_f32 v27, v27
    v_exp_f32 v28, v28
    v_exp_f32 v29, v29
    v_exp_f32 v30, v30
    v_exp_f32 v31, v31
    s_nop 0
    v_cvt_pk_bf16_f32 v112, v16, v17
    v_cvt_pk_bf16_f32 v113, v18, v19
    v_cvt_pk_bf16_f32 v114, v20, v21
    v_cvt_pk_bf16_f32 v115, v22, v23
    v_cvt_pk_bf16_f32 v116, v24, v25
    v_cvt_pk_bf16_f32 v117, v26, v27
    v_cvt_pk_bf16_f32 v118, v28, v29
    v_cvt_pk_bf16_f32 v119, v30, v31
    s_nop 1
    v_mfma_f32_32x32x16_bf16 v[80:95], v[128:131], v[112:115], v[80:95]
    v_mfma_f32_32x32x16_bf16 v[80:95], v[132:135], v[116:119], v[80:95]
    v_exp_f32 v32, v32
    v_exp_f32 v33, v33
    v_exp_f32 v34, v34
    v_exp_f32 v35, v35
    v_exp_f32 v36, v36
    v_exp_f32 v37, v37
    v_exp_f32 v38, v38
    v_exp_f32 v39, v39
    v_exp_f32 v40, v40
    v_exp_f32 v41, v41
    v_exp_f32 v42, v42
    v_exp_f32 v43, v43
    v_exp_f32 v44, v44
    v_exp_f32 v45, v45
    v_exp_f32 v46, v46
    v_exp_f32 v47, v47
    s_nop 0
    v_cvt_pk_bf16_f32 v112, v32, v33
    v_cvt_pk_bf16_f32 v113, v34, v35
    v_cvt_pk_bf16_f32 v114, v36, v37
    v_cvt_pk_bf16_f32 v115, v38, v39
    v_cvt_pk_bf16_f32 v116, v40, v41
    v_cvt_pk_bf16_f32 v117, v42, v43
    v_cvt_pk_bf16_f32 v118, v44, v45
    v_cvt_pk_bf16_f32 v119, v46, v47
    s_nop 1
    v_mfma_f32_32x32x16_bf16 v[96:111], v[128:131], v[112:115], v[96:111]
    v_mfma_f32_32x32x16_bf16 v[96:111], v[132:135], v[116:119], v[96:111]
    v_add_u32 v6, 16384, v6
    v_add_u32 v7, v146, v7
    s_add_u32 s74, s74, 1
    s_cmp_lt_u32 s74, 8
    s_cbranch_scc1 L3_re1
    s_branch L3_chk
L3_ok:
    s_lshl_b32 s80, s42, 3
    s_lshl_b32 s81, s44, 1
    s_add_u32 s80, s80, s81
    s_lshl_b32 s80, s80, 5
    s_add_u32 s80, s80, s43
    s_lshl_b32 s80, s80, 10
    s_add_u32 s80, s80, 5242880
    s_add_u32 s81, s80, 32768
    v_rcp_f32 v2, v88
    s_nop 0
    v_pk_mul_f32 v[80:81], v[80:81], v[2:3] op_sel_hi:[1,0]
    v_pk_mul_f32 v[82:83], v[82:83], v[2:3] op_sel_hi:[1,0]
    v_pk_mul_f32 v[84:85], v[84:85], v[2:3] op_sel_hi:[1,0]
    v_pk_mul_f32 v[86:87], v[86:87], v[2:3] op_sel_hi:[1,0]
    v_cvt_pk_bf16_f32 v4, v80, v81
    v_cvt_pk_bf16_f32 v5, v82, v83
    v_cvt_pk_bf16_f32 v6, v84, v85
    v_cvt_pk_bf16_f32 v7, v86, v87
    s_cmp_eq_u32 s46, 0
    s_cbranch_scc1 L_ms_o0_s
    buffer_store_dwordx4 v[4:7], v252, s[12:15], s80 offen
    s_branch L_ms_o0_d
L_ms_o0_s:
    buffer_store_dwordx4 v[4:7], v252, s[12:15], s80 offen sc1
L_ms_o0_d:
    v_rcp_f32 v2, v104
    s_nop 0
    v_pk_mul_f32 v[96:97], v[96:97], v[2:3] op_sel_hi:[1,0]
    v_pk_mul_f32 v[98:99], v[98:99], v[2:3] op_sel_hi:[1,0]
    v_pk_mul_f32 v[100:101], v[100:101], v[2:3] op_sel_hi:[1,0]
    v_pk_mul_f32 v[102:103], v[102:103], v[2:3] op_sel_hi:[1,0]
    v_cvt_pk_bf16_f32 v8, v96, v97
    v_cvt_pk_bf16_f32 v9, v98, v99
    v_cvt_pk_bf16_f32 v10, v100, v101
    v_cvt_pk_bf16_f32 v11, v102, v103
    s_cmp_eq_u32 s46, 0
    s_cbranch_scc1 L_ms_o1_s
    buffer_store_dwordx4 v[8:11], v252, s[12:15], s81 offen
    s_branch L_ms_o1_d
L_ms_o1_s:
    buffer_store_dwordx4 v[8:11], v252, s[12:15], s81 offen sc1
L_ms_o1_d:
    s_waitcnt vmcnt(0)
    s_barrier
    s_lshr_b32 s100, s43, 3
    s_and_b32 s101, s43, 7
    s_lshr_b32 s3, s43, 4
    s_and_b32 s80, s43, 15
    s_mul_i32 s80, s80, 174768
    s_lshr_b32 s51, s80, 16
    s_lshr_b32 s87, s44, 1
    s_and_b32 s88, s44, 1
    s_lshl_b32 s89, s42, 3
    s_lshl_b32 s81, s100, 1
    s_add_u32 s89, s89, s81
    s_add_u32 s89, s89, s88
    v_lshrrev_b32 v9, 5, v253
    v_bfe_u32 v11, v253, 2, 2
    v_lshl_add_u32 v9, v9, 2, v11
    v_lshlrev_b32 v10, 7, v9
    v_bfe_u32 v9, v253, 4, 1
    s_lshl_b32 s81, s87, 1
    v_or_b32 v9, s81, v9
    v_bfe_u32 v11, v253, 3, 1
    v_lshlrev_b32 v11, 1, v11
    v_xor_b32 v9, v9, v11
    v_lshl_add_u32 v10, v9, 5, v10
    v_and_b32 v9, 3, v253
    v_lshl_add_u32 v10, v9, 3, v10
    v_add_u32 v10, 98304, v10
    s_lshl_b32 s81, s88, 15
    s_add_u32 s81, s81, 98304
    v_add_u32 v8, s81, v252
    v_lshlrev_b32 v64, 16, v148
    v_and_b32 v65, 0xffff0000, v148
    v_lshlrev_b32 v66, 16, v149
    v_and_b32 v67, 0xffff0000, v149
    v_lshlrev_b32 v68, 16, v150
    v_and_b32 v69, 0xffff0000, v150
    v_lshlrev_b32 v70, 16, v151
    v_and_b32 v71, 0xffff0000, v151
    v_lshlrev_b32 v72, 16, v152
    v_and_b32 v73, 0xffff0000, v152
    v_lshlrev_b32 v74, 16, v153
    v_and_b32 v75, 0xffff0000, v153
    v_lshlrev_b32 v76, 16, v154
    v_and_b32 v77, 0xffff0000, v154
    v_lshlrev_b32 v78, 16, v155
    v_and_b32 v79, 0xffff0000, v155
    s_lshl_b32 s81, s101, 1
    s_add_u32 s81, s81, s87
    s_lshl_b32 s91, s89, 4
    s_add_u32 s91, s91, s81
    s_lshl_b32 s91, s91, 8
    s_add_u32 s91, s91, 15204352
    s_lshl_b32 s90, s89, 5
    s_lshl_b32 s81, s81, 1
    s_add_u32 s90, s90, s81
    s_lshl_b32 s90, s90, 10
    s_add_u32 s90, s90, 7340032
    s_barrier
    ds_read_b64_tr_b16 v[80:81], v10 offset:0
    ds_read_b64_tr_b16 v[82:83], v10 offset:1024
    ds_read_b64_tr_b16 v[84:85], v10 offset:2048
    ds_read_b64_tr_b16 v[86:87], v10 offset:3072
    ds_read_b64_tr_b16 v[88:89], v10 offset:4096
    ds_read_b64_tr_b16 v[90:91], v10 offset:5120
    ds_read_b64_tr_b16 v[92:93], v10 offset:6144
    ds_read_b64_tr_b16 v[94:95], v10 offset:7168
    ds_read_b64_tr_b16 v[96:97], v10 offset:8192
    ds_read_b64_tr_b16 v[98:99], v10 offset:9216
    ds_read_b64_tr_b16 v[100:101], v10 offset:10240
    ds_read_b64_tr_b16 v[102:103], v10 offset:11264
    ds_read_b64_tr_b16 v[104:105], v10 offset:12288
    ds_read_b64_tr_b16 v[106:107], v10 offset:13312
    s_waitcnt lgkmcnt(0)
    ds_read_b64_tr_b16 v[108:109], v10 offset:14336
    ds_read_b64_tr_b16 v[110:111], v10 offset:15360
    ds_read_b64_tr_b16 v[112:113], v10 offset:16384
    ds_read_b64_tr_b16 v[114:115], v10 offset:17408
    ds_read_b64_tr_b16 v[116:117], v10 offset:18432
    ds_read_b64_tr_b16 v[118:119], v10 offset:19456
    ds_read_b64_tr_b16 v[120:121], v10 offset:20480
    ds_read_b64_tr_b16 v[122:123], v10 offset:21504
    ds_read_b64_tr_b16 v[124:125], v10 offset:22528
    ds_read_b64_tr_b16 v[126:127], v10 offset:23552
    ds_read_b64_tr_b16 v[128:129], v10 offset:24576
    ds_read_b64_tr_b16 v[130:131], v10 offset:25600
    ds_read_b64_tr_b16 v[132:133], v10 offset:26624
    ds_read_b64_tr_b16 v[134:135], v10 offset:27648
    s_waitcnt lgkmcnt(0)
    ds_read_b64_tr_b16 v[136:137], v10 offset:28672
    ds_read_b64_tr_b16 v[138:139], v10 offset:29696
    ds_read_b64_tr_b16 v[140:141], v10 offset:30720
    ds_read_b64_tr_b16 v[142:143], v10 offset:31744
    ds_read_b64_tr_b16 v[144:145], v10 offset:32768
    ds_read_b64_tr_b16 v[146:147], v10 offset:33792
    ds_read_b64_tr_b16 v[148:149], v10 offset:34816
    ds_read_b64_tr_b16 v[150:151], v10 offset:35840
    ds_read_b64_tr_b16 v[152:153], v10 offset:36864
    ds_read_b64_tr_b16 v[154:155], v10 offset:37888
    ds_read_b64_tr_b16 v[156:157], v10 offset:38912
    ds_read_b64_tr_b16 v[158:159], v10 offset:39936
    ds_read_b64_tr_b16 v[160:161], v10 offset:40960
    ds_read_b64_tr_b16 v[162:163], v10 offset:41984
    s_waitcnt lgkmcnt(0)
    ds_read_b64_tr_b16 v[164:165], v10 offset:43008
    ds_read_b64_tr_b16 v[166:167], v10 offset:44032
    ds_read_b64_tr_b16 v[168:169], v10 offset:45056
    ds_read_b64_tr_b16 v[170:171], v10 offset:46080
    ds_read_b64_tr_b16 v[172:173], v10 offset:47104
    ds_read_b64_tr_b16 v[174:175], v10 offset:48128
    ds_read_b64_tr_b16 v[176:177], v10 offset:49152
    ds_read_b64_tr_b16 v[178:179], v10 offset:50176
    ds_read_b64_tr_b16 v[180:181], v10 offset:51200
    ds_read_b64_tr_b16 v[182:183], v10 offset:52224
    ds_read_b64_tr_b16 v[184:185], v10 offset:53248
    ds_read_b64_tr_b16 v[186:187], v10 offset:54272
    ds_read_b64_tr_b16 v[188:189], v10 offset:55296
    ds_read_b64_tr_b16 v[190:191], v10 offset:56320
    s_waitcnt lgkmcnt(0)
    ds_read_b64_tr_b16 v[192:193], v10 offset:57344
    ds_read_b64_tr_b16 v[194:195], v10 offset:58368
    ds_read_b64_tr_b16 v[196:197], v10 offset:59392
    ds_read_b64_tr_b16 v[198:199], v10 offset:60416
    ds_read_b64_tr_b16 v[200:201], v10 offset:61440
    ds_read_b64_tr_b16 v[202:203], v10 offset:62464
    ds_read_b64_tr_b16 v[204:205], v10 offset:63488
    ds_read_b64_tr_b16 v[206:207], v10 offset:64512
    s_waitcnt lgkmcnt(0)
    s_barrier
    s_barrier
    ds_read_b128 v[16:19], v8 offset:0
    ds_read_b128 v[20:23], v8 offset:1024
    ds_read_b128 v[24:27], v8 offset:2048
    ds_read_b128 v[28:31], v8 offset:3072
    s_waitcnt lgkmcnt(3)
    v_mfma_f32_32x32x16_bf16 v[48:63], v[80:83], v[16:19], 0
    ds_read_b128 v[16:19], v8 offset:4096
    s_waitcnt lgkmcnt(3)
    v_mfma_f32_32x32x16_bf16 v[48:63], v[84:87], v[20:23], v[48:63]
    ds_read_b128 v[20:23], v8 offset:5120
    s_waitcnt lgkmcnt(3)
    v_mfma_f32_32x32x16_bf16 v[48:63], v[88:91], v[24:27], v[48:63]
    ds_read_b128 v[24:27], v8 offset:6144
    s_waitcnt lgkmcnt(3)
    v_mfma_f32_32x32x16_bf16 v[48:63], v[92:95], v[28:31], v[48:63]
    ds_read_b128 v[28:31], v8 offset:7168
    s_waitcnt lgkmcnt(3)
    v_mfma_f32_32x32x16_bf16 v[48:63], v[96:99], v[16:19], v[48:63]
    s_waitcnt lgkmcnt(2)
    v_mfma_f32_32x32x16_bf16 v[48:63], v[100:103], v[20:23], v[48:63]
    s_waitcnt lgkmcnt(1)
    v_mfma_f32_32x32x16_bf16 v[48:63], v[104:107], v[24:27], v[48:63]
    s_waitcnt lgkmcnt(0)
    v_mfma_f32_32x32x16_bf16 v[48:63], v[108:111], v[28:31], v[48:63]
    s_barrier
    ds_read_b128 v[16:19], v8 offset:8192
    ds_read_b128 v[20:23], v8 offset:9216
    ds_read_b128 v[24:27], v8 offset:10240
    ds_read_b128 v[28:31], v8 offset:11264
    s_waitcnt lgkmcnt(3)
    v_mfma_f32_32x32x16_bf16 v[48:63], v[112:115], v[16:19], v[48:63]
    ds_read_b128 v[16:19], v8 offset:12288
    s_waitcnt lgkmcnt(3)
    v_mfma_f32_32x32x16_bf16 v[48:63], v[116:119], v[20:23], v[48:63]
    ds_read_b128 v[20:23], v8 offset:13312
    s_waitcnt lgkmcnt(3)
    v_mfma_f32_32x32x16_bf16 v[48:63], v[120:123], v[24:27], v[48:63]
    ds_read_b128 v[24:27], v8 offset:14336
    s_waitcnt lgkmcnt(3)
    v_mfma_f32_32x32x16_bf16 v[48:63], v[124:127], v[28:31], v[48:63]
    ds_read_b128 v[28:31], v8 offset:15360
    s_waitcnt lgkmcnt(3)
    v_mfma_f32_32x32x16_bf16 v[48:63], v[128:131], v[16:19], v[48:63]
    s_waitcnt lgkmcnt(2)
    v_mfma_f32_32x32x16_bf16 v[48:63], v[132:135], v[20:23], v[48:63]
    s_waitcnt lgkmcnt(1)
    v_mfma_f32_32x32x16_bf16 v[48:63], v[136:139], v[24:27], v[48:63]
    s_waitcnt lgkmcnt(0)
    v_mfma_f32_32x32x16_bf16 v[48:63], v[140:143], v[28:31], v[48:63]
    s_barrier
    ds_read_b128 v[16:19], v8 offset:16384
    ds_read_b128 v[20:23], v8 offset:17408
    ds_read_b128 v[24:27], v8 offset:18432
    ds_read_b128 v[28:31], v8 offset:19456
    s_waitcnt lgkmcnt(3)
    v_mfma_f32_32x32x16_bf16 v[48:63], v[144:147], v[16:19], v[48:63]
    ds_read_b128 v[16:19], v8 offset:20480
    s_waitcnt lgkmcnt(3)
    v_mfma_f32_32x32x16_bf16 v[48:63], v[148:151], v[20:23], v[48:63]
    ds_read_b128 v[20:23], v8 offset:21504
    s_waitcnt lgkmcnt(3)
    v_mfma_f32_32x32x16_bf16 v[48:63], v[152:155], v[24:27], v[48:63]
    ds_read_b128 v[24:27], v8 offset:22528
    s_waitcnt lgkmcnt(3)
    v_mfma_f32_32x32x16_bf16 v[48:63], v[156:159], v[28:31], v[48:63]
    ds_read_b128 v[28:31], v8 offset:23552
    s_waitcnt lgkmcnt(3)
    v_mfma_f32_32x32x16_bf16 v[48:63], v[160:163], v[16:19], v[48:63]
    s_waitcnt lgkmcnt(2)
    v_mfma_f32_32x32x16_bf16 v[48:63], v[164:167], v[20:23], v[48:63]
    s_waitcnt lgkmcnt(1)
    v_mfma_f32_32x32x16_bf16 v[48:63], v[168:171], v[24:27], v[48:63]
    s_waitcnt lgkmcnt(0)
    v_mfma_f32_32x32x16_bf16 v[48:63], v[172:175], v[28:31], v[48:63]
    s_barrier
    ds_read_b128 v[16:19], v8 offset:24576
    ds_read_b128 v[20:23], v8 offset:25600
    ds_read_b128 v[24:27], v8 offset:26624
    ds_read_b128 v[28:31], v8 offset:27648
    s_waitcnt lgkmcnt(3)
    v_mfma_f32_32x32x16_bf16 v[48:63], v[176:179], v[16:19], v[48:63]
    ds_read_b128 v[16:19], v8 offset:28672
    s_waitcnt lgkmcnt(3)
    v_mfma_f32_32x32x16_bf16 v[48:63], v[180:183], v[20:23], v[48:63]
    ds_read_b128 v[20:23], v8 offset:29696
    s_waitcnt lgkmcnt(3)
    v_mfma_f32_32x32x16_bf16 v[48:63], v[184:187], v[24:27], v[48:63]
    ds_read_b128 v[24:27], v8 offset:30720
    s_waitcnt lgkmcnt(3)
    v_mfma_f32_32x32x16_bf16 v[48:63], v[188:191], v[28:31], v[48:63]
    ds_read_b128 v[28:31], v8 offset:31744
    s_waitcnt lgkmcnt(3)
    v_mfma_f32_32x32x16_bf16 v[48:63], v[192:195], v[16:19], v[48:63]
    s_waitcnt lgkmcnt(2)
    v_mfma_f32_32x32x16_bf16 v[48:63], v[196:199], v[20:23], v[48:63]
    s_waitcnt lgkmcnt(1)
    v_mfma_f32_32x32x16_bf16 v[48:63], v[200:203], v[24:27], v[48:63]
    s_waitcnt lgkmcnt(0)
    v_mfma_f32_32x32x16_bf16 v[48:63], v[204:207], v[28:31], v[48:63]
    v_and_b32 v8, 31, v253
    v_lshlrev_b32 v8, 3, v8
    s_nop 7
    s_nop 1
    v_pk_add_f32 v[48:49], v[48:49], v[64:65]
    v_pk_add_f32 v[50:51], v[50:51], v[66:67]
    v_pk_add_f32 v[52:53], v[52:53], v[68:69]
    v_pk_add_f32 v[54:55], v[54:55], v[70:71]
    v_pk_add_f32 v[56:57], v[56:57], v[72:73]
    v_pk_add_f32 v[58:59], v[58:59], v[74:75]
    v_pk_add_f32 v[60:61], v[60:61], v[76:77]
    v_pk_add_f32 v[62:63], v[62:63], v[78:79]
    v_cvt_pk_bf16_f32 v32, v48, v49
    v_cvt_pk_bf16_f32 v33, v50, v51
    v_cvt_pk_bf16_f32 v34, v52, v53
    v_cvt_pk_bf16_f32 v35, v54, v55
    v_cvt_pk_bf16_f32 v36, v56, v57
    v_cvt_pk_bf16_f32 v37, v58, v59
    v_cvt_pk_bf16_f32 v38, v60, v61
    v_cvt_pk_bf16_f32 v39, v62, v63
    s_cmp_eq_u32 s46, 0
    s_cbranch_scc1 L_ms_h3_s
    buffer_store_dwordx4 v[32:35], v252, s[12:15], s90 offen
    buffer_store_dwordx4 v[36:39], v252, s[12:15], s90 offen offset:1024
    s_branch L_ms_h3_d
L_ms_h3_s:
    buffer_store_dwordx4 v[32:35], v252, s[12:15], s90 offen sc1
    buffer_store_dwordx4 v[36:39], v252, s[12:15], s90 offen offset:1024 sc1
L_ms_h3_d:
    v_lshlrev_b32 v48, 16, v32
    v_and_b32 v49, 0xffff0000, v32
    v_lshlrev_b32 v50, 16, v33
    v_and_b32 v51, 0xffff0000, v33
    v_lshlrev_b32 v52, 16, v34
    v_and_b32 v53, 0xffff0000, v34
    v_lshlrev_b32 v54, 16, v35
    v_and_b32 v55, 0xffff0000, v35
    v_lshlrev_b32 v56, 16, v36
    v_and_b32 v57, 0xffff0000, v36
    v_lshlrev_b32 v58, 16, v37
    v_and_b32 v59, 0xffff0000, v37
    v_lshlrev_b32 v60, 16, v38
    v_and_b32 v61, 0xffff0000, v38
    v_lshlrev_b32 v62, 16, v39
    v_and_b32 v63, 0xffff0000, v39
    v_pk_mul_f32 v[16:17], v[48:49], v[48:49]
    v_pk_add_f32 v[18:19], v[48:49], v[50:51]
    v_pk_fma_f32 v[16:17], v[50:51], v[50:51], v[16:17]
    v_pk_fma_f32 v[16:17], v[52:53], v[52:53], v[16:17]
    v_pk_fma_f32 v[16:17], v[54:55], v[54:55], v[16:17]
    v_pk_fma_f32 v[16:17], v[56:57], v[56:57], v[16:17]
    v_pk_fma_f32 v[16:17], v[58:59], v[58:59], v[16:17]
    v_pk_fma_f32 v[16:17], v[60:61], v[60:61], v[16:17]
    v_pk_fma_f32 v[16:17], v[62:63], v[62:63], v[16:17]
    v_pk_add_f32 v[18:19], v[18:19], v[52:53]
    v_pk_add_f32 v[18:19], v[18:19], v[54:55]
    v_pk_add_f32 v[18:19], v[18:19], v[56:57]
    v_pk_add_f32 v[18:19], v[18:19], v[58:59]
    v_pk_add_f32 v[18:19], v[18:19], v[60:61]
    v_pk_add_f32 v[18:19], v[18:19], v[62:63]
    v_add_f32 v40, v18, v19
    v_add_f32 v41, v16, v17
    s_nop 0
    v_mov_b32 v42, v40
    v_mov_b32 v43, v41
    s_nop 1
    v_permlane32_swap_b32 v40, v42
    v_permlane32_swap_b32 v41, v43
    s_nop 0
    v_pk_add_f32 v[40:41], v[40:41], v[42:43]
    s_mov_b64 exec, 0xffffffff
    s_cmp_eq_u32 s46, 0
    s_cbranch_scc1 L_ms_hs3_s
    buffer_store_dwordx2 v[40:41], v8, s[12:15], s91 offen
    s_branch L_ms_hs3_d
L_ms_hs3_s:
    buffer_store_dwordx2 v[40:41], v8, s[12:15], s91 offen sc1
L_ms_hs3_d:
    s_mov_b64 exec, -1
    s_lshl_b32 s89, s42, 3
    s_lshl_b32 s81, s3, 2
    s_add_u32 s89, s89, s81
    s_add_u32 s89, s89, s44
    s_lshl_b32 s93, s89, 15
    s_add_u32 s93, s93, 7340032
    s_lshl_b32 s94, s89, 12
    s_add_u32 s94, s94, 15204352
    s_mul_i32 s92, s89, 86
    s_lshl_b32 s81, s51, 1
    s_add_u32 s92, s92, s81
    s_lshl_b32 s92, s92, 10
    s_add_u32 s92, s92, 9437184
    v_and_b32 v12, 31, v253
    v_lshlrev_b32 v12, 3, v12
    v_lshrrev_b32 v14, 5, v253
    v_lshl_add_u32 v12, v14, 11, v12
    v_lshrrev_b32 v14, 5, v253
    v_bfe_u32 v15, v253, 2, 2
    v_lshl_add_u32 v14, v14, 2, v15
    v_mul_u32_u24 v13, 192, v14
    v_bfe_u32 v15, v253, 4, 1
    v_lshl_add_u32 v13, v15, 5, v13
    v_and_b32 v15, 3, v253
    v_lshl_add_u32 v13, v15, 3, v13
    v_add_u32 v11, 49152, v13
    v_lshrrev_b32 v9, 5, v253
    v_lshlrev_b32 v9, 4, v9
    v_add_u32 v9, 147456, v9
    s_waitcnt vmcnt(0)
    s_barrier
    s_barrier
    buffer_load_dwordx4 v[16:19], v252, s[12:15], s93 offen offset:0 sc1
    buffer_load_dwordx4 v[20:23], v252, s[12:15], s93 offen offset:1024 sc1
    buffer_load_dwordx4 v[24:27], v252, s[12:15], s93 offen offset:2048 sc1
    buffer_load_dwordx4 v[28:31], v252, s[12:15], s93 offen offset:3072 sc1
    s_add_u32 s93, s93, 4096
    buffer_load_dwordx4 v[32:35], v252, s[12:15], s93 offen offset:0 sc1
    buffer_load_dwordx4 v[36:39], v252, s[12:15], s93 offen offset:1024 sc1
    buffer_load_dwordx4 v[40:43], v252, s[12:15], s93 offen offset:2048 sc1
    buffer_load_dwordx4 v[44:47], v252, s[12:15], s93 offen offset:3072 sc1
    ds_read_b64_tr_b16 v[192:193], v13 offset:0
    ds_read_b64_tr_b16 v[194:195], v13 offset:1536
    ds_read_b64_tr_b16 v[196:197], v13 offset:64
    ds_read_b64_tr_b16 v[198:199], v13 offset:1600
    ds_read_b64_tr_b16 v[200:201], v13 offset:128
    ds_read_b64_tr_b16 v[202:203], v13 offset:1664
    ds_read_b64_tr_b16 v[204:205], v13 offset:3072
    ds_read_b64_tr_b16 v[206:207], v13 offset:4608
    ds_read_b64_tr_b16 v[208:209], v13 offset:3136
    ds_read_b64_tr_b16 v[210:211], v13 offset:4672
    ds_read_b64_tr_b16 v[212:213], v13 offset:3200
    ds_read_b64_tr_b16 v[214:215], v13 offset:4736
    s_waitcnt vmcnt(7) lgkmcnt(6)
    v_mfma_f32_32x32x16_bf16 v[144:159], v[192:195], v[16:19], 0
    ds_read_b64_tr_b16 v[216:217], v13 offset:6144
    ds_read_b64_tr_b16 v[218:219], v13 offset:7680
    s_add_u32 s93, s93, 4096
    buffer_load_dwordx4 v[48:51], v252, s[12:15], s93 offen offset:0 sc1
    v_mfma_f32_32x32x16_bf16 v[160:175], v[196:199], v[16:19], 0
    ds_read_b64_tr_b16 v[220:221], v13 offset:6208
    ds_read_b64_tr_b16 v[222:223], v13 offset:7744
    v_mfma_f32_32x32x16_bf16 v[176:191], v[200:203], v[16:19], 0
    ds_read_b64_tr_b16 v[224:225], v13 offset:6272
    ds_read_b64_tr_b16 v[226:227], v13 offset:7808
    s_waitcnt vmcnt(7) lgkmcnt(6)
    v_mfma_f32_32x32x16_bf16 v[144:159], v[204:207], v[20:23], v[144:159]
    ds_read_b64_tr_b16 v[192:193], v13 offset:9216
    ds_read_b64_tr_b16 v[194:195], v13 offset:10752
    buffer_load_dwordx4 v[52:55], v252, s[12:15], s93 offen offset:1024 sc1
    v_mfma_f32_32x32x16_bf16 v[160:175], v[208:211], v[20:23], v[160:175]
    ds_read_b64_tr_b16 v[196:197], v13 offset:9280
    ds_read_b64_tr_b16 v[198:199], v13 offset:10816
    v_mfma_f32_32x32x16_bf16 v[176:191], v[212:215], v[20:23], v[176:191]
    ds_read_b64_tr_b16 v[200:201], v13 offset:9344
    ds_read_b64_tr_b16 v[202:203], v13 offset:10880
    s_waitcnt vmcnt(7) lgkmcnt(6)
    v_mfma_f32_32x32x16_bf16 v[144:159], v[216:219], v[24:27], v[144:159]
    ds_read_b64_tr_b16 v[204:205], v13 offset:12288
    ds_read_b64_tr_b16 v[206:207], v13 offset:13824
    buffer_load_dwordx4 v[56:59], v252, s[12:15], s93 offen offset:2048 sc1
    v_mfma_f32_32x32x16_bf16 v[160:175], v[220:223], v[24:27], v[160:175]
    ds_read_b64_tr_b16 v[208:209], v13 offset:12352
    ds_read_b64_tr_b16 v[210:211], v13 offset:13888
    v_mfma_f32_32x32x16_bf16 v[176:191], v[224:227], v[24:27], v[176:191]
    ds_read_b64_tr_b16 v[212:213], v13 offset:12416
    ds_read_b64_tr_b16 v[214:215], v13 offset:13952
    s_waitcnt vmcnt(7) lgkmcnt(6)
    v_mfma_f32_32x32x16_bf16 v[144:159], v[192:195], v[28:31], v[144:159]
    ds_read_b64_tr_b16 v[216:217], v13 offset:15360
    ds_read_b64_tr_b16 v[218:219], v13 offset:16896
    buffer_load_dwordx4 v[60:63], v252, s[12:15], s93 offen offset:3072 sc1
    v_mfma_f32_32x32x16_bf16 v[160:175], v[196:199], v[28:31], v[160:175]
    ds_read_b64_tr_b16 v[220:221], v13 offset:15424
    ds_read_b64_tr_b16 v[222:223], v13 offset:16960
    v_mfma_f32_32x32x16_bf16 v[176:191], v[200:203], v[28:31], v[176:191]
    ds_read_b64_tr_b16 v[224:225], v13 offset:15488
    ds_read_b64_tr_b16 v[226:227], v13 offset:17024
    s_waitcnt vmcnt(7) lgkmcnt(6)
    v_mfma_f32_32x32x16_bf16 v[144:159], v[204:207], v[32:35], v[144:159]
    ds_read_b64_tr_b16 v[192:193], v13 offset:18432
    ds_read_b64_tr_b16 v[194:195], v13 offset:19968
    s_add_u32 s93, s93, 4096
    buffer_load_dwordx4 v[64:67], v252, s[12:15], s93 offen offset:0 sc1
    v_mfma_f32_32x32x16_bf16 v[160:175], v[208:211], v[32:35], v[160:175]
    ds_read_b64_tr_b16 v[196:197], v13 offset:18496
    ds_read_b64_tr_b16 v[198:199], v13 offset:20032
    v_mfma_f32_32x32x16_bf16 v[176:191], v[212:215], v[32:35], v[176:191]
    ds_read_b64_tr_b16 v[200:201], v13 offset:18560
    ds_read_b64_tr_b16 v[202:203], v13 offset:20096
    s_waitcnt vmcnt(7) lgkmcnt(6)
    v_mfma_f32_32x32x16_bf16 v[144:159], v[216:219], v[36:39], v[144:159]
    ds_read_b64_tr_b16 v[204:205], v13 offset:21504
    ds_read_b64_tr_b16 v[206:207], v13 offset:23040
    buffer_load_dwordx4 v[68:71], v252, s[12:15], s93 offen offset:1024 sc1
    v_mfma_f32_32x32x16_bf16 v[160:175], v[220:223], v[36:39], v[160:175]
    ds_read_b64_tr_b16 v[208:209], v13 offset:21568
    ds_read_b64_tr_b16 v[210:211], v13 offset:23104
    v_mfma_f32_32x32x16_bf16 v[176:191], v[224:227], v[36:39], v[176:191]
    ds_read_b64_tr_b16 v[212:213], v13 offset:21632
    ds_read_b64_tr_b16 v[214:215], v13 offset:23168
    s_waitcnt vmcnt(7) lgkmcnt(6)
    v_mfma_f32_32x32x16_bf16 v[144:159], v[192:195], v[40:43], v[144:159]
    ds_read_b64_tr_b16 v[216:217], v13 offset:24576
    ds_read_b64_tr_b16 v[218:219], v13 offset:26112
    buffer_load_dwordx4 v[72:75], v252, s[12:15], s93 offen offset:2048 sc1
    v_mfma_f32_32x32x16_bf16 v[160:175], v[196:199], v[40:43], v[160:175]
    ds_read_b64_tr_b16 v[220:221], v13 offset:24640
    ds_read_b64_tr_b16 v[222:223], v13 offset:26176
    v_mfma_f32_32x32x16_bf16 v[176:191], v[200:203], v[40:43], v[176:191]
    ds_read_b64_tr_b16 v[224:225], v13 offset:24704
    ds_read_b64_tr_b16 v[226:227], v13 offset:26240
    s_waitcnt vmcnt(7) lgkmcnt(6)
    v_mfma_f32_32x32x16_bf16 v[144:159], v[204:207], v[44:47], v[144:159]
    ds_read_b64_tr_b16 v[192:193], v13 offset:27648
    ds_read_b64_tr_b16 v[194:195], v13 offset:29184
    buffer_load_dwordx4 v[76:79], v252, s[12:15], s93 offen offset:3072 sc1
    v_mfma_f32_32x32x16_bf16 v[160:175], v[208:211], v[44:47], v[160:175]
    ds_read_b64_tr_b16 v[196:197], v13 offset:27712
    ds_read_b64_tr_b16 v[198:199], v13 offset:29248
    v_mfma_f32_32x32x16_bf16 v[176:191], v[212:215], v[44:47], v[176:191]
    ds_read_b64_tr_b16 v[200:201], v13 offset:27776
    ds_read_b64_tr_b16 v[202:203], v13 offset:29312
    s_waitcnt vmcnt(7) lgkmcnt(6)
    v_mfma_f32_32x32x16_bf16 v[144:159], v[216:219], v[48:51], v[144:159]
    ds_read_b64_tr_b16 v[204:205], v13 offset:30720
    ds_read_b64_tr_b16 v[206:207], v13 offset:32256
    s_add_u32 s93, s93, 4096
    buffer_load_dwordx4 v[80:83], v252, s[12:15], s93 offen offset:0 sc1
    v_mfma_f32_32x32x16_bf16 v[160:175], v[220:223], v[48:51], v[160:175]
    ds_read_b64_tr_b16 v[208:209], v13 offset:30784
    ds_read_b64_tr_b16 v[210:211], v13 offset:32320
    v_mfma_f32_32x32x16_bf16 v[176:191], v[224:227], v[48:51], v[176:191]
    ds_read_b64_tr_b16 v[212:213], v13 offset:30848
    ds_read_b64_tr_b16 v[214:215], v13 offset:32384
    s_waitcnt vmcnt(7) lgkmcnt(6)
    v_mfma_f32_32x32x16_bf16 v[144:159], v[192:195], v[52:55], v[144:159]
    ds_read_b64_tr_b16 v[216:217], v13 offset:33792
    ds_read_b64_tr_b16 v[218:219], v13 offset:35328
    buffer_load_dwordx4 v[84:87], v252, s[12:15], s93 offen offset:1024 sc1
    v_mfma_f32_32x32x16_bf16 v[160:175], v[196:199], v[52:55], v[160:175]
    ds_read_b64_tr_b16 v[220:221], v13 offset:33856
    ds_read_b64_tr_b16 v[222:223], v13 offset:35392
    v_mfma_f32_32x32x16_bf16 v[176:191], v[200:203], v[52:55], v[176:191]
    ds_read_b64_tr_b16 v[224:225], v13 offset:33920
    ds_read_b64_tr_b16 v[226:227], v13 offset:35456
    s_waitcnt vmcnt(7) lgkmcnt(6)
    v_mfma_f32_32x32x16_bf16 v[144:159], v[204:207], v[56:59], v[144:159]
    ds_read_b64_tr_b16 v[192:193], v13 offset:36864
    ds_read_b64_tr_b16 v[194:195], v13 offset:38400
    buffer_load_dwordx4 v[88:91], v252, s[12:15], s93 offen offset:2048 sc1
    v_mfma_f32_32x32x16_bf16 v[160:175], v[208:211], v[56:59], v[160:175]
    ds_read_b64_tr_b16 v[196:197], v13 offset:36928
    ds_read_b64_tr_b16 v[198:199], v13 offset:38464
    v_mfma_f32_32x32x16_bf16 v[176:191], v[212:215], v[56:59], v[176:191]
    ds_read_b64_tr_b16 v[200:201], v13 offset:36992
    ds_read_b64_tr_b16 v[202:203], v13 offset:38528
    s_waitcnt vmcnt(7) lgkmcnt(6)
    v_mfma_f32_32x32x16_bf16 v[144:159], v[216:219], v[60:63], v[144:159]
    ds_read_b64_tr_b16 v[204:205], v13 offset:39936
    ds_read_b64_tr_b16 v[206:207], v13 offset:41472
    buffer_load_dwordx4 v[92:95], v252, s[12:15], s93 offen offset:3072 sc1
    v_mfma_f32_32x32x16_bf16 v[160:175], v[220:223], v[60:63], v[160:175]
    ds_read_b64_tr_b16 v[208:209], v13 offset:40000
    ds_read_b64_tr_b16 v[210:211], v13 offset:41536
    v_mfma_f32_32x32x16_bf16 v[176:191], v[224:227], v[60:63], v[176:191]
    ds_read_b64_tr_b16 v[212:213], v13 offset:40064
    ds_read_b64_tr_b16 v[214:215], v13 offset:41600
    s_waitcnt vmcnt(7) lgkmcnt(6)
    v_mfma_f32_32x32x16_bf16 v[144:159], v[192:195], v[64:67], v[144:159]
    ds_read_b64_tr_b16 v[216:217], v13 offset:43008
    ds_read_b64_tr_b16 v[218:219], v13 offset:44544
    s_add_u32 s93, s93, 4096
    buffer_load_dwordx4 v[96:99], v252, s[12:15], s93 offen offset:0 sc1
    v_mfma_f32_32x32x16_bf16 v[160:175], v[196:199], v[64:67], v[160:175]
    ds_read_b64_tr_b16 v[220:221], v13 offset:43072
    ds_read_b64_tr_b16 v[222:223], v13 offset:44608
    v_mfma_f32_32x32x16_bf16 v[176:191], v[200:203], v[64:67], v[176:191]
    ds_read_b64_tr_b16 v[224:225], v13 offset:43136
    ds_read_b64_tr_b16 v[226:227], v13 offset:44672
    s_waitcnt vmcnt(7) lgkmcnt(6)
    v_mfma_f32_32x32x16_bf16 v[144:159], v[204:207], v[68:71], v[144:159]
    ds_read_b64_tr_b16 v[192:193], v13 offset:46080
    ds_read_b64_tr_b16 v[194:195], v13 offset:47616
    buffer_load_dwordx4 v[100:103], v252, s[12:15], s93 offen offset:1024 sc1
    v_mfma_f32_32x32x16_bf16 v[160:175], v[208:211], v[68:71], v[160:175]
    ds_read_b64_tr_b16 v[196:197], v13 offset:46144
    ds_read_b64_tr_b16 v[198:199], v13 offset:47680
    v_mfma_f32_32x32x16_bf16 v[176:191], v[212:215], v[68:71], v[176:191]
    ds_read_b64_tr_b16 v[200:201], v13 offset:46208
    ds_read_b64_tr_b16 v[202:203], v13 offset:47744
    s_waitcnt vmcnt(7) lgkmcnt(6)
    v_mfma_f32_32x32x16_bf16 v[144:159], v[216:219], v[72:75], v[144:159]
    ds_read_b64_tr_b16 v[204:205], v11 offset:0
    ds_read_b64_tr_b16 v[206:207], v11 offset:1536
    buffer_load_dwordx4 v[104:107], v252, s[12:15], s93 offen offset:2048 sc1
    v_mfma_f32_32x32x16_bf16 v[160:175], v[220:223], v[72:75], v[160:175]
    ds_read_b64_tr_b16 v[208:209], v11 offset:64
    ds_read_b64_tr_b16 v[210:211], v11 offset:1600
    v_mfma_f32_32x32x16_bf16 v[176:191], v[224:227], v[72:75], v[176:191]
    ds_read_b64_tr_b16 v[212:213], v11 offset:128
    ds_read_b64_tr_b16 v[214:215], v11 offset:1664
    s_waitcnt vmcnt(7) lgkmcnt(6)
    v_mfma_f32_32x32x16_bf16 v[144:159], v[192:195], v[76:79], v[144:159]
    ds_read_b64_tr_b16 v[216:217], v11 offset:3072
    ds_read_b64_tr_b16 v[218:219], v11 offset:4608
    buffer_load_dwordx4 v[108:111], v252, s[12:15], s93 offen offset:3072 sc1
    v_mfma_f32_32x32x16_bf16 v[160:175], v[196:199], v[76:79], v[160:175]
    ds_read_b64_tr_b16 v[220:221], v11 offset:3136
    ds_read_b64_tr_b16 v[222:223], v11 offset:4672
    v_mfma_f32_32x32x16_bf16 v[176:191], v[200:203], v[76:79], v[176:191]
    ds_read_b64_tr_b16 v[224:225], v11 offset:3200
    ds_read_b64_tr_b16 v[226:227], v11 offset:4736
    s_waitcnt vmcnt(7) lgkmcnt(6)
    v_mfma_f32_32x32x16_bf16 v[144:159], v[204:207], v[80:83], v[144:159]
    ds_read_b64_tr_b16 v[192:193], v11 offset:6144
    ds_read_b64_tr_b16 v[194:195], v11 offset:7680
    s_add_u32 s93, s93, 4096
    buffer_load_dwordx4 v[112:115], v252, s[12:15], s93 offen offset:0 sc1
    v_mfma_f32_32x32x16_bf16 v[160:175], v[208:211], v[80:83], v[160:175]
    ds_read_b64_tr_b16 v[196:197], v11 offset:6208
    ds_read_b64_tr_b16 v[198:199], v11 offset:7744
    v_mfma_f32_32x32x16_bf16 v[176:191], v[212:215], v[80:83], v[176:191]
    ds_read_b64_tr_b16 v[200:201], v11 offset:6272
    ds_read_b64_tr_b16 v[202:203], v11 offset:7808
    s_waitcnt vmcnt(7) lgkmcnt(6)
    v_mfma_f32_32x32x16_bf16 v[144:159], v[216:219], v[84:87], v[144:159]
    ds_read_b64_tr_b16 v[204:205], v11 offset:9216
    ds_read_b64_tr_b16 v[206:207], v11 offset:10752
    buffer_load_dwordx4 v[116:119], v252, s[12:15], s93 offen offset:1024 sc1
    v_mfma_f32_32x32x16_bf16 v[160:175], v[220:223], v[84:87], v[160:175]
    ds_read_b64_tr_b16 v[208:209], v11 offset:9280
    ds_read_b64_tr_b16 v[210:211], v11 offset:10816
    v_mfma_f32_32x32x16_bf16 v[176:191], v[224:227], v[84:87], v[176:191]
    ds_read_b64_tr_b16 v[212:213], v11 offset:9344
    ds_read_b64_tr_b16 v[214:215], v11 offset:10880
    s_waitcnt vmcnt(7) lgkmcnt(6)
    v_mfma_f32_32x32x16_bf16 v[144:159], v[192:195], v[88:91], v[144:159]
    ds_read_b64_tr_b16 v[216:217], v11 offset:12288
    ds_read_b64_tr_b16 v[218:219], v11 offset:13824
    buffer_load_dwordx4 v[120:123], v252, s[12:15], s93 offen offset:2048 sc1
    v_mfma_f32_32x32x16_bf16 v[160:175], v[196:199], v[88:91], v[160:175]
    ds_read_b64_tr_b16 v[220:221], v11 offset:12352
    ds_read_b64_tr_b16 v[222:223], v11 offset:13888
    v_mfma_f32_32x32x16_bf16 v[176:191], v[200:203], v[88:91], v[176:191]
    ds_read_b64_tr_b16 v[224:225], v11 offset:12416
    ds_read_b64_tr_b16 v[226:227], v11 offset:13952
    s_waitcnt vmcnt(7) lgkmcnt(6)
    v_mfma_f32_32x32x16_bf16 v[144:159], v[204:207], v[92:95], v[144:159]
    ds_read_b64_tr_b16 v[192:193], v11 offset:15360
    ds_read_b64_tr_b16 v[194:195], v11 offset:16896
    buffer_load_dwordx4 v[124:127], v252, s[12:15], s93 offen offset:3072 sc1
    v_mfma_f32_32x32x16_bf16 v[160:175], v[208:211], v[92:95], v[160:175]
    ds_read_b64_tr_b16 v[196:197], v11 offset:15424
    ds_read_b64_tr_b16 v[198:199], v11 offset:16960
    v_mfma_f32_32x32x16_bf16 v[176:191], v[212:215], v[92:95], v[176:191]
    ds_read_b64_tr_b16 v[200:201], v11 offset:15488
    ds_read_b64_tr_b16 v[202:203], v11 offset:17024
    s_waitcnt vmcnt(7) lgkmcnt(6)
    v_mfma_f32_32x32x16_bf16 v[144:159], v[216:219], v[96:99], v[144:159]
    ds_read_b64_tr_b16 v[204:205], v11 offset:18432
    ds_read_b64_tr_b16 v[206:207], v11 offset:19968
    s_add_u32 s93, s93, 4096
    buffer_load_dwordx4 v[128:131], v252, s[12:15], s93 offen offset:0 sc1
    v_mfma_f32_32x32x16_bf16 v[160:175], v[220:223], v[96:99], v[160:175]
    ds_read_b64_tr_b16 v[208:209], v11 offset:18496
    ds_read_b64_tr_b16 v[210:211], v11 offset:20032
    v_mfma_f32_32x32x16_bf16 v[176:191], v[224:227], v[96:99], v[176:191]
    ds_read_b64_tr_b16 v[212:213], v11 offset:18560
    ds_read_b64_tr_b16 v[214:215], v11 offset:20096
    s_waitcnt vmcnt(7) lgkmcnt(6)
    v_mfma_f32_32x32x16_bf16 v[144:159], v[192:195], v[100:103], v[144:159]
    ds_read_b64_tr_b16 v[216:217], v11 offset:21504
    ds_read_b64_tr_b16 v[218:219], v11 offset:23040
    buffer_load_dwordx4 v[132:135], v252, s[12:15], s93 offen offset:1024 sc1
    v_mfma_f32_32x32x16_bf16 v[160:175], v[196:199], v[100:103], v[160:175]
    ds_read_b64_tr_b16 v[220:221], v11 offset:21568
    ds_read_b64_tr_b16 v[222:223], v11 offset:23104
    v_mfma_f32_32x32x16_bf16 v[176:191], v[200:203], v[100:103], v[176:191]
    ds_read_b64_tr_b16 v[224:225], v11 offset:21632
    ds_read_b64_tr_b16 v[226:227], v11 offset:23168
    s_waitcnt vmcnt(7) lgkmcnt(6)
    v_mfma_f32_32x32x16_bf16 v[144:159], v[204:207], v[104:107], v[144:159]
    ds_read_b64_tr_b16 v[192:193], v11 offset:24576
    ds_read_b64_tr_b16 v[194:195], v11 offset:26112
    buffer_load_dwordx4 v[136:139], v252, s[12:15], s93 offen offset:2048 sc1
    v_mfma_f32_32x32x16_bf16 v[160:175], v[208:211], v[104:107], v[160:175]
    ds_read_b64_tr_b16 v[196:197], v11 offset:24640
    ds_read_b64_tr_b16 v[198:199], v11 offset:26176
    v_mfma_f32_32x32x16_bf16 v[176:191], v[212:215], v[104:107], v[176:191]
    ds_read_b64_tr_b16 v[200:201], v11 offset:24704
    ds_read_b64_tr_b16 v[202:203], v11 offset:26240
    s_waitcnt vmcnt(7) lgkmcnt(6)
    v_mfma_f32_32x32x16_bf16 v[144:159], v[216:219], v[108:111], v[144:159]
    ds_read_b64_tr_b16 v[204:205], v11 offset:27648
    ds_read_b64_tr_b16 v[206:207], v11 offset:29184
    buffer_load_dwordx4 v[140:143], v252, s[12:15], s93 offen offset:3072 sc1
    v_mfma_f32_32x32x16_bf16 v[160:175], v[220:223], v[108:111], v[160:175]
    ds_read_b64_tr_b16 v[208:209], v11 offset:27712
    ds_read_b64_tr_b16 v[210:211], v11 offset:29248
    v_mfma_f32_32x32x16_bf16 v[176:191], v[224:227], v[108:111], v[176:191]
    ds_read_b64_tr_b16 v[212:213], v11 offset:27776
    ds_read_b64_tr_b16 v[214:215], v11 offset:29312
    s_waitcnt vmcnt(7) lgkmcnt(6)
    v_mfma_f32_32x32x16_bf16 v[144:159], v[192:195], v[112:115], v[144:159]
    ds_read_b64_tr_b16 v[216:217], v11 offset:30720
    ds_read_b64_tr_b16 v[218:219], v11 offset:32256
    buffer_load_dwordx2 v[228:229], v12, s[12:15], s94 offen offset:0 sc1
    v_mfma_f32_32x32x16_bf16 v[160:175], v[196:199], v[112:115], v[160:175]
    ds_read_b64_tr_b16 v[220:221], v11 offset:30784
    ds_read_b64_tr_b16 v[222:223], v11 offset:32320
    v_mfma_f32_32x32x16_bf16 v[176:191], v[200:203], v[112:115], v[176:191]
    ds_read_b64_tr_b16 v[224:225], v11 offset:30848
    ds_read_b64_tr_b16 v[226:227], v11 offset:32384
    s_waitcnt vmcnt(7) lgkmcnt(6)
    v_mfma_f32_32x32x16_bf16 v[144:159], v[204:207], v[116:119], v[144:159]
    ds_read_b64_tr_b16 v[192:193], v11 offset:33792
    ds_read_b64_tr_b16 v[194:195], v11 offset:35328
    buffer_load_dwordx2 v[230:231], v12, s[12:15], s94 offen offset:256 sc1
    v_mfma_f32_32x32x16_bf16 v[160:175], v[208:211], v[116:119], v[160:175]
    ds_read_b64_tr_b16 v[196:197], v11 offset:33856
    ds_read_b64_tr_b16 v[198:199], v11 offset:35392
    v_mfma_f32_32x32x16_bf16 v[176:191], v[212:215], v[116:119], v[176:191]
    ds_read_b64_tr_b16 v[200:201], v11 offset:33920
    ds_read_b64_tr_b16 v[202:203], v11 offset:35456
    s_waitcnt vmcnt(7) lgkmcnt(6)
    v_mfma_f32_32x32x16_bf16 v[144:159], v[216:219], v[120:123], v[144:159]
    ds_read_b64_tr_b16 v[204:205], v11 offset:36864
    ds_read_b64_tr_b16 v[206:207], v11 offset:38400
    buffer_load_dwordx2 v[232:233], v12, s[12:15], s94 offen offset:512 sc1
    v_mfma_f32_32x32x16_bf16 v[160:175], v[220:223], v[120:123], v[160:175]
    ds_read_b64_tr_b16 v[208:209], v11 offset:36928
    ds_read_b64_tr_b16 v[210:211], v11 offset:38464
    v_mfma_f32_32x32x16_bf16 v[176:191], v[224:227], v[120:123], v[176:191]
    ds_read_b64_tr_b16 v[212:213], v11 offset:36992
    ds_read_b64_tr_b16 v[214:215], v11 offset:38528
    s_waitcnt vmcnt(7) lgkmcnt(6)
    v_mfma_f32_32x32x16_bf16 v[144:159], v[192:195], v[124:127], v[144:159]
    ds_read_b64_tr_b16 v[216:217], v11 offset:39936
    ds_read_b64_tr_b16 v[218:219], v11 offset:41472
    buffer_load_dwordx2 v[234:235], v12, s[12:15], s94 offen offset:768 sc1
    v_mfma_f32_32x32x16_bf16 v[160:175], v[196:199], v[124:127], v[160:175]
    ds_read_b64_tr_b16 v[220:221], v11 offset:40000
    ds_read_b64_tr_b16 v[222:223], v11 offset:41536
    v_mfma_f32_32x32x16_bf16 v[176:191], v[200:203], v[124:127], v[176:191]
    ds_read_b64_tr_b16 v[224:225], v11 offset:40064
    ds_read_b64_tr_b16 v[226:227], v11 offset:41600
    s_waitcnt vmcnt(7) lgkmcnt(6)
    v_mfma_f32_32x32x16_bf16 v[144:159], v[204:207], v[128:131], v[144:159]
    ds_read_b64_tr_b16 v[192:193], v11 offset:43008
    ds_read_b64_tr_b16 v[194:195], v11 offset:44544
    buffer_load_dwordx2 v[236:237], v12, s[12:15], s94 offen offset:1024 sc1
    v_mfma_f32_32x32x16_bf16 v[160:175], v[208:211], v[128:131], v[160:175]
    ds_read_b64_tr_b16 v[196:197], v11 offset:43072
    ds_read_b64_tr_b16 v[198:199], v11 offset:44608
    v_mfma_f32_32x32x16_bf16 v[176:191], v[212:215], v[128:131], v[176:191]
    ds_read_b64_tr_b16 v[200:201], v11 offset:43136
    ds_read_b64_tr_b16 v[202:203], v11 offset:44672
    s_waitcnt vmcnt(7) lgkmcnt(6)
    v_mfma_f32_32x32x16_bf16 v[144:159], v[216:219], v[132:135], v[144:159]
    ds_read_b64_tr_b16 v[204:205], v11 offset:46080
    ds_read_b64_tr_b16 v[206:207], v11 offset:47616
    buffer_load_dwordx2 v[238:239], v12, s[12:15], s94 offen offset:1280 sc1
    v_mfma_f32_32x32x16_bf16 v[160:175], v[220:223], v[132:135], v[160:175]
    ds_read_b64_tr_b16 v[208:209], v11 offset:46144
    ds_read_b64_tr_b16 v[210:211], v11 offset:47680
    v_mfma_f32_32x32x16_bf16 v[176:191], v[224:227], v[132:135], v[176:191]
    ds_read_b64_tr_b16 v[212:213], v11 offset:46208
    ds_read_b64_tr_b16 v[214:215], v11 offset:47744
    s_waitcnt vmcnt(7) lgkmcnt(6)
    v_mfma_f32_32x32x16_bf16 v[144:159], v[192:195], v[136:139], v[144:159]
    buffer_load_dwordx2 v[240:241], v12, s[12:15], s94 offen offset:1536 sc1
    v_mfma_f32_32x32x16_bf16 v[160:175], v[196:199], v[136:139], v[160:175]
    v_mfma_f32_32x32x16_bf16 v[176:191], v[200:203], v[136:139], v[176:191]
    s_waitcnt vmcnt(7) lgkmcnt(0)
    v_mfma_f32_32x32x16_bf16 v[144:159], v[204:207], v[140:143], v[144:159]
    buffer_load_dwordx2 v[242:243], v12, s[12:15], s94 offen offset:1792 sc1
    v_mfma_f32_32x32x16_bf16 v[160:175], v[208:211], v[140:143], v[160:175]
    v_mfma_f32_32x32x16_bf16 v[176:191], v[212:215], v[140:143], v[176:191]
    ds_read_b128 v[16:19], v9 offset:0
    ds_read_b128 v[20:23], v9 offset:32
    ds_read_b128 v[24:27], v9 offset:64
    ds_read_b128 v[28:31], v9 offset:96
    ds_read_b128 v[32:35], v9 offset:128
    ds_read_b128 v[36:39], v9 offset:160
    ds_read_b128 v[40:43], v9 offset:192
    s_waitcnt lgkmcnt(4)
    ds_read_b128 v[44:47], v9 offset:224
    ds_read_b128 v[48:51], v9 offset:256
    ds_read_b128 v[52:55], v9 offset:288
    ds_read_b128 v[56:59], v9 offset:320
    ds_read_b128 v[60:63], v9 offset:352
    s_waitcnt vmcnt(0)
    v_pk_add_f32 v[228:229], v[228:229], v[236:237]
    v_pk_add_f32 v[230:231], v[230:231], v[238:239]
    v_pk_add_f32 v[232:233], v[232:233], v[240:241]
    v_pk_add_f32 v[234:235], v[234:235], v[242:243]
    v_pk_add_f32 v[228:229], v[228:229], v[232:233]
    v_pk_add_f32 v[230:231], v[230:231], v[234:235]
    v_pk_add_f32 v[228:229], v[228:229], v[230:231]
    s_waitcnt lgkmcnt(4)
    ds_read_b128 v[64:67], v9 offset:384
    ds_read_b128 v[68:71], v9 offset:416
    ds_read_b128 v[72:75], v9 offset:448
    ds_read_b128 v[76:79], v9 offset:480
    ds_read_b128 v[80:83], v9 offset:512
    ds_read_b128 v[84:87], v9 offset:544
    ds_read_b128 v[88:91], v9 offset:576
    s_waitcnt lgkmcnt(4)
    ds_read_b128 v[92:95], v9 offset:608
    ds_read_b128 v[96:99], v9 offset:640
    ds_read_b128 v[100:103], v9 offset:672
    ds_read_b128 v[104:107], v9 offset:704
    ds_read_b128 v[108:111], v9 offset:736
    v_mov_b32 v230, v228
    v_mov_b32 v231, v229
    s_nop 1
    v_permlane32_swap_b32 v228, v230
    v_permlane32_swap_b32 v229, v231
    s_nop 0
    v_pk_add_f32 v[228:229], v[228:229], v[230:231]
    v_mul_f32 v228, 0x3b000000, v228
    v_mul_f32 v229, 0x3b000000, v229
    v_fma_f32 v229, -v228, v228, v229
    v_add_f32 v229, 0x3727c5ac, v229
    v_rsq_f32 v230, v229
    s_nop 0
    v_mul_f32 v232, v228, v230
    s_waitcnt lgkmcnt(0)
    v_pk_fma_f32 v[64:65], v[16:17], v[232:233], v[64:65] op_sel_hi:[1,0,1] neg_lo:[0,1,0] neg_hi:[0,1,0]
    v_pk_fma_f32 v[66:67], v[18:19], v[232:233], v[66:67] op_sel_hi:[1,0,1] neg_lo:[0,1,0] neg_hi:[0,1,0]
    v_pk_fma_f32 v[68:69], v[20:21], v[232:233], v[68:69] op_sel_hi:[1,0,1] neg_lo:[0,1,0] neg_hi:[0,1,0]
    v_pk_fma_f32 v[70:71], v[22:23], v[232:233], v[70:71] op_sel_hi:[1,0,1] neg_lo:[0,1,0] neg_hi:[0,1,0]
    v_pk_fma_f32 v[144:145], v[144:145], v[230:231], v[64:65] op_sel_hi:[1,0,1]
    v_pk_fma_f32 v[146:147], v[146:147], v[230:231], v[66:67] op_sel_hi:[1,0,1]
    v_pk_fma_f32 v[148:149], v[148:149], v[230:231], v[68:69] op_sel_hi:[1,0,1]
    v_pk_fma_f32 v[150:151], v[150:151], v[230:231], v[70:71] op_sel_hi:[1,0,1]
    v_max_f32 v144, 0, v144
    v_max_f32 v145, 0, v145
    v_max_f32 v146, 0, v146
    v_max_f32 v147, 0, v147
    v_max_f32 v148, 0, v148
    v_max_f32 v149, 0, v149
    v_max_f32 v150, 0, v150
    v_max_f32 v151, 0, v151
    v_pk_mul_f32 v[144:145], v[144:145], v[144:145]
    v_pk_mul_f32 v[146:147], v[146:147], v[146:147]
    v_pk_mul_f32 v[148:149], v[148:149], v[148:149]
    v_pk_mul_f32 v[150:151], v[150:151], v[150:151]
    v_cvt_pk_bf16_f32 v112, v144, v145
    v_cvt_pk_bf16_f32 v113, v146, v147
    v_cvt_pk_bf16_f32 v114, v148, v149
    v_cvt_pk_bf16_f32 v115, v150, v151
    s_cmp_eq_u32 s46, 0
    s_cbranch_scc1 L_ms_g30_s
    buffer_store_dwordx4 v[112:115], v252, s[12:15], s92 offen offset:0
    s_branch L_ms_g30_d
L_ms_g30_s:
    buffer_store_dwordx4 v[112:115], v252, s[12:15], s92 offen offset:0 sc1
L_ms_g30_d:
    v_pk_fma_f32 v[72:73], v[24:25], v[232:233], v[72:73] op_sel_hi:[1,0,1] neg_lo:[0,1,0] neg_hi:[0,1,0]
    v_pk_fma_f32 v[74:75], v[26:27], v[232:233], v[74:75] op_sel_hi:[1,0,1] neg_lo:[0,1,0] neg_hi:[0,1,0]
    v_pk_fma_f32 v[76:77], v[28:29], v[232:233], v[76:77] op_sel_hi:[1,0,1] neg_lo:[0,1,0] neg_hi:[0,1,0]
    v_pk_fma_f32 v[78:79], v[30:31], v[232:233], v[78:79] op_sel_hi:[1,0,1] neg_lo:[0,1,0] neg_hi:[0,1,0]
    v_pk_fma_f32 v[152:153], v[152:153], v[230:231], v[72:73] op_sel_hi:[1,0,1]
    v_pk_fma_f32 v[154:155], v[154:155], v[230:231], v[74:75] op_sel_hi:[1,0,1]
    v_pk_fma_f32 v[156:157], v[156:157], v[230:231], v[76:77] op_sel_hi:[1,0,1]
    v_pk_fma_f32 v[158:159], v[158:159], v[230:231], v[78:79] op_sel_hi:[1,0,1]
    v_max_f32 v152, 0, v152
    v_max_f32 v153, 0, v153
    v_max_f32 v154, 0, v154
    v_max_f32 v155, 0, v155
    v_max_f32 v156, 0, v156
    v_max_f32 v157, 0, v157
    v_max_f32 v158, 0, v158
    v_max_f32 v159, 0, v159
    v_pk_mul_f32 v[152:153], v[152:153], v[152:153]
    v_pk_mul_f32 v[154:155], v[154:155], v[154:155]
    v_pk_mul_f32 v[156:157], v[156:157], v[156:157]
    v_pk_mul_f32 v[158:159], v[158:159], v[158:159]
    v_cvt_pk_bf16_f32 v116, v152, v153
    v_cvt_pk_bf16_f32 v117, v154, v155
    v_cvt_pk_bf16_f32 v118, v156, v157
    v_cvt_pk_bf16_f32 v119, v158, v159
    s_cmp_eq_u32 s46, 0
    s_cbranch_scc1 L_ms_g31_s
    buffer_store_dwordx4 v[116:119], v252, s[12:15], s92 offen offset:1024
    s_branch L_ms_g31_d
L_ms_g31_s:
    buffer_store_dwordx4 v[116:119], v252, s[12:15], s92 offen offset:1024 sc1
L_ms_g31_d:
    v_pk_fma_f32 v[80:81], v[32:33], v[232:233], v[80:81] op_sel_hi:[1,0,1] neg_lo:[0,1,0] neg_hi:[0,1,0]
    v_pk_fma_f32 v[82:83], v[34:35], v[232:233], v[82:83] op_sel_hi:[1,0,1] neg_lo:[0,1,0] neg_hi:[0,1,0]
    v_pk_fma_f32 v[84:85], v[36:37], v[232:233], v[84:85] op_sel_hi:[1,0,1] neg_lo:[0,1,0] neg_hi:[0,1,0]
    v_pk_fma_f32 v[86:87], v[38:39], v[232:233], v[86:87] op_sel_hi:[1,0,1] neg_lo:[0,1,0] neg_hi:[0,1,0]
    v_pk_fma_f32 v[160:161], v[160:161], v[230:231], v[80:81] op_sel_hi:[1,0,1]
    v_pk_fma_f32 v[162:163], v[162:163], v[230:231], v[82:83] op_sel_hi:[1,0,1]
    v_pk_fma_f32 v[164:165], v[164:165], v[230:231], v[84:85] op_sel_hi:[1,0,1]
    v_pk_fma_f32 v[166:167], v[166:167], v[230:231], v[86:87] op_sel_hi:[1,0,1]
    v_max_f32 v160, 0, v160
    v_max_f32 v161, 0, v161
    v_max_f32 v162, 0, v162
    v_max_f32 v163, 0, v163
    v_max_f32 v164, 0, v164
    v_max_f32 v165, 0, v165
    v_max_f32 v166, 0, v166
    v_max_f32 v167, 0, v167
    v_pk_mul_f32 v[160:161], v[160:161], v[160:161]
    v_pk_mul_f32 v[162:163], v[162:163], v[162:163]
    v_pk_mul_f32 v[164:165], v[164:165], v[164:165]
    v_pk_mul_f32 v[166:167], v[166:167], v[166:167]
    v_cvt_pk_bf16_f32 v120, v160, v161
    v_cvt_pk_bf16_f32 v121, v162, v163
    v_cvt_pk_bf16_f32 v122, v164, v165
    v_cvt_pk_bf16_f32 v123, v166, v167
    s_cmp_eq_u32 s46, 0
    s_cbranch_scc1 L_ms_g32_s
    buffer_store_dwordx4 v[120:123], v252, s[12:15], s92 offen offset:2048
    s_branch L_ms_g32_d
L_ms_g32_s:
    buffer_store_dwordx4 v[120:123], v252, s[12:15], s92 offen offset:2048 sc1
L_ms_g32_d:
    v_pk_fma_f32 v[88:89], v[40:41], v[232:233], v[88:89] op_sel_hi:[1,0,1] neg_lo:[0,1,0] neg_hi:[0,1,0]
    v_pk_fma_f32 v[90:91], v[42:43], v[232:233], v[90:91] op_sel_hi:[1,0,1] neg_lo:[0,1,0] neg_hi:[0,1,0]
    v_pk_fma_f32 v[92:93], v[44:45], v[232:233], v[92:93] op_sel_hi:[1,0,1] neg_lo:[0,1,0] neg_hi:[0,1,0]
    v_pk_fma_f32 v[94:95], v[46:47], v[232:233], v[94:95] op_sel_hi:[1,0,1] neg_lo:[0,1,0] neg_hi:[0,1,0]
    v_pk_fma_f32 v[168:169], v[168:169], v[230:231], v[88:89] op_sel_hi:[1,0,1]
    v_pk_fma_f32 v[170:171], v[170:171], v[230:231], v[90:91] op_sel_hi:[1,0,1]
    v_pk_fma_f32 v[172:173], v[172:173], v[230:231], v[92:93] op_sel_hi:[1,0,1]
    v_pk_fma_f32 v[174:175], v[174:175], v[230:231], v[94:95] op_sel_hi:[1,0,1]
    v_max_f32 v168, 0, v168
    v_max_f32 v169, 0, v169
    v_max_f32 v170, 0, v170
    v_max_f32 v171, 0, v171
    v_max_f32 v172, 0, v172
    v_max_f32 v173, 0, v173
    v_max_f32 v174, 0, v174
    v_max_f32 v175, 0, v175
    v_pk_mul_f32 v[168:169], v[168:169], v[168:169]
    v_pk_mul_f32 v[170:171], v[170:171], v[170:171]
    v_pk_mul_f32 v[172:173], v[172:173], v[172:173]
    v_pk_mul_f32 v[174:175], v[174:175], v[174:175]
    v_cvt_pk_bf16_f32 v124, v168, v169
    v_cvt_pk_bf16_f32 v125, v170, v171
    v_cvt_pk_bf16_f32 v126, v172, v173
    v_cvt_pk_bf16_f32 v127, v174, v175
    s_cmp_eq_u32 s46, 0
    s_cbranch_scc1 L_ms_g33_s
    buffer_store_dwordx4 v[124:127], v252, s[12:15], s92 offen offset:3072
    s_branch L_ms_g33_d
L_ms_g33_s:
    buffer_store_dwordx4 v[124:127], v252, s[12:15], s92 offen offset:3072 sc1
L_ms_g33_d:
    v_pk_fma_f32 v[96:97], v[48:49], v[232:233], v[96:97] op_sel_hi:[1,0,1] neg_lo:[0,1,0] neg_hi:[0,1,0]
    v_pk_fma_f32 v[98:99], v[50:51], v[232:233], v[98:99] op_sel_hi:[1,0,1] neg_lo:[0,1,0] neg_hi:[0,1,0]
    v_pk_fma_f32 v[100:101], v[52:53], v[232:233], v[100:101] op_sel_hi:[1,0,1] neg_lo:[0,1,0] neg_hi:[0,1,0]
    v_pk_fma_f32 v[102:103], v[54:55], v[232:233], v[102:103] op_sel_hi:[1,0,1] neg_lo:[0,1,0] neg_hi:[0,1,0]
    v_pk_fma_f32 v[176:177], v[176:177], v[230:231], v[96:97] op_sel_hi:[1,0,1]
    v_pk_fma_f32 v[178:179], v[178:179], v[230:231], v[98:99] op_sel_hi:[1,0,1]
    v_pk_fma_f32 v[180:181], v[180:181], v[230:231], v[100:101] op_sel_hi:[1,0,1]
    v_pk_fma_f32 v[182:183], v[182:183], v[230:231], v[102:103] op_sel_hi:[1,0,1]
    v_max_f32 v176, 0, v176
    v_max_f32 v177, 0, v177
    v_max_f32 v178, 0, v178
    v_max_f32 v179, 0, v179
    v_max_f32 v180, 0, v180
    v_max_f32 v181, 0, v181
    v_max_f32 v182, 0, v182
    v_max_f32 v183, 0, v183
    v_pk_mul_f32 v[176:177], v[176:177], v[176:177]
    v_pk_mul_f32 v[178:179], v[178:179], v[178:179]
    v_pk_mul_f32 v[180:181], v[180:181], v[180:181]
    v_pk_mul_f32 v[182:183], v[182:183], v[182:183]
    v_cvt_pk_bf16_f32 v128, v176, v177
    v_cvt_pk_bf16_f32 v129, v178, v179
    v_cvt_pk_bf16_f32 v130, v180, v181
    v_cvt_pk_bf16_f32 v131, v182, v183
    s_add_u32 s92, s92, 4096
    s_cmp_eq_u32 s46, 0
    s_cbranch_scc1 L_ms_g34_s
    buffer_store_dwordx4 v[128:131], v252, s[12:15], s92 offen offset:0
    s_branch L_ms_g34_d
L_ms_g34_s:
    buffer_store_dwordx4 v[128:131], v252, s[12:15], s92 offen offset:0 sc1
L_ms_g34_d:
    v_pk_fma_f32 v[104:105], v[56:57], v[232:233], v[104:105] op_sel_hi:[1,0,1] neg_lo:[0,1,0] neg_hi:[0,1,0]
    v_pk_fma_f32 v[106:107], v[58:59], v[232:233], v[106:107] op_sel_hi:[1,0,1] neg_lo:[0,1,0] neg_hi:[0,1,0]
    v_pk_fma_f32 v[108:109], v[60:61], v[232:233], v[108:109] op_sel_hi:[1,0,1] neg_lo:[0,1,0] neg_hi:[0,1,0]
    v_pk_fma_f32 v[110:111], v[62:63], v[232:233], v[110:111] op_sel_hi:[1,0,1] neg_lo:[0,1,0] neg_hi:[0,1,0]
    v_pk_fma_f32 v[184:185], v[184:185], v[230:231], v[104:105] op_sel_hi:[1,0,1]
    v_pk_fma_f32 v[186:187], v[186:187], v[230:231], v[106:107] op_sel_hi:[1,0,1]
    v_pk_fma_f32 v[188:189], v[188:189], v[230:231], v[108:109] op_sel_hi:[1,0,1]
    v_pk_fma_f32 v[190:191], v[190:191], v[230:231], v[110:111] op_sel_hi:[1,0,1]
    v_max_f32 v184, 0, v184
    v_max_f32 v185, 0, v185
    v_max_f32 v186, 0, v186
    v_max_f32 v187, 0, v187
    v_max_f32 v188, 0, v188
    v_max_f32 v189, 0, v189
    v_max_f32 v190, 0, v190
    v_max_f32 v191, 0, v191
    v_pk_mul_f32 v[184:185], v[184:185], v[184:185]
    v_pk_mul_f32 v[186:187], v[186:187], v[186:187]
    v_pk_mul_f32 v[188:189], v[188:189], v[188:189]
    v_pk_mul_f32 v[190:191], v[190:191], v[190:191]
    v_cvt_pk_bf16_f32 v132, v184, v185
    v_cvt_pk_bf16_f32 v133, v186, v187
    v_cvt_pk_bf16_f32 v134, v188, v189
    v_cvt_pk_bf16_f32 v135, v190, v191
    s_cmp_eq_u32 s46, 0
    s_cbranch_scc1 L_ms_g35_s
    buffer_store_dwordx4 v[132:135], v252, s[12:15], s92 offen offset:1024
    s_branch L_ms_g35_d
L_ms_g35_s:
    buffer_store_dwordx4 v[132:135], v252, s[12:15], s92 offen offset:1024 sc1
L_ms_g35_d:
    s_lshl_b32 s81, s42, 3
    s_lshl_b32 s82, s100, 1
    s_add_u32 s81, s81, s82
    s_and_b32 s82, s44, 1
    s_add_u32 s81, s81, s82
    s_mul_i32 s81, s81, 86
    s_lshr_b32 s83, s44, 1
    s_mul_i32 s84, s83, 43
    s_add_u32 s81, s81, s84
    s_lshl_b32 s81, s81, 10
    s_add_u32 s93, s81, 9437184
    s_lshl_b32 s94, s83, 14
    s_lshl_b32 s82, s82, 10
    s_add_u32 s94, s94, s82
    s_waitcnt vmcnt(0)
    s_barrier
    s_barrier
    s_add_u32 m0, s94, 0
    s_add_u32 s83, s93, 0
    buffer_load_dwordx4 v252, s[12:15], s83 offen sc1 lds
    s_add_u32 m0, s94, 2048
    s_add_u32 s83, s93, 1024
    buffer_load_dwordx4 v252, s[12:15], s83 offen sc1 lds
    s_add_u32 m0, s94, 4096
    s_add_u32 s83, s93, 2048
    buffer_load_dwordx4 v252, s[12:15], s83 offen sc1 lds
    s_add_u32 m0, s94, 6144
    s_add_u32 s83, s93, 3072
    buffer_load_dwordx4 v252, s[12:15], s83 offen sc1 lds
    s_add_u32 m0, s94, 8192
    s_add_u32 s83, s93, 4096
    buffer_load_dwordx4 v252, s[12:15], s83 offen sc1 lds
    s_add_u32 m0, s94, 10240
    s_add_u32 s83, s93, 5120
    buffer_load_dwordx4 v252, s[12:15], s83 offen sc1 lds
    s_add_u32 m0, s94, 12288
    s_add_u32 s83, s93, 6144
    buffer_load_dwordx4 v252, s[12:15], s83 offen sc1 lds
    s_add_u32 m0, s94, 14336
    s_add_u32 s83, s93, 7168
    buffer_load_dwordx4 v252, s[12:15], s83 offen sc1 lds
    s_add_u32 m0, s94, 32768
    s_add_u32 s83, s93, 8192
    buffer_load_dwordx4 v252, s[12:15], s83 offen sc1 lds
    s_add_u32 m0, s94, 34816
    s_add_u32 s83, s93, 9216
    buffer_load_dwordx4 v252, s[12:15], s83 offen sc1 lds
    s_add_u32 m0, s94, 36864
    s_add_u32 s83, s93, 10240
    buffer_load_dwordx4 v252, s[12:15], s83 offen sc1 lds
    s_add_u32 m0, s94, 38912
    s_add_u32 s83, s93, 11264
    buffer_load_dwordx4 v252, s[12:15], s83 offen sc1 lds
    s_add_u32 m0, s94, 40960
    s_add_u32 s83, s93, 12288
    buffer_load_dwordx4 v252, s[12:15], s83 offen sc1 lds
    s_add_u32 m0, s94, 43008
    s_add_u32 s83, s93, 13312
    buffer_load_dwordx4 v252, s[12:15], s83 offen sc1 lds
    s_add_u32 m0, s94, 45056
    s_add_u32 s83, s93, 14336
    buffer_load_dwordx4 v252, s[12:15], s83 offen sc1 lds
    s_add_u32 m0, s94, 47104
    s_add_u32 s83, s93, 15360
    buffer_load_dwordx4 v252, s[12:15], s83 offen sc1 lds
    s_add_u32 m0, s94, 65536
    s_add_u32 s83, s93, 16384
    buffer_load_dwordx4 v252, s[12:15], s83 offen sc1 lds
    s_add_u32 m0, s94, 67584
    s_add_u32 s83, s93, 17408
    buffer_load_dwordx4 v252, s[12:15], s83 offen sc1 lds
    s_add_u32 m0, s94, 69632
    s_add_u32 s83, s93, 18432
    buffer_load_dwordx4 v252, s[12:15], s83 offen sc1 lds
    s_add_u32 m0, s94, 71680
    s_add_u32 s83, s93, 19456
    buffer_load_dwordx4 v252, s[12:15], s83 offen sc1 lds
    s_add_u32 m0, s94, 73728
    s_add_u32 s83, s93, 20480
    buffer_load_dwordx4 v252, s[12:15], s83 offen sc1 lds
    s_add_u32 m0, s94, 75776
    s_add_u32 s83, s93, 21504
    buffer_load_dwordx4 v252, s[12:15], s83 offen sc1 lds
    s_add_u32 m0, s94, 77824
    s_add_u32 s83, s93, 22528
    buffer_load_dwordx4 v252, s[12:15], s83 offen sc1 lds
    s_add_u32 m0, s94, 79872
    s_add_u32 s83, s93, 23552
    buffer_load_dwordx4 v252, s[12:15], s83 offen sc1 lds
    s_waitcnt vmcnt(16)
    s_barrier
    s_add_u32 m0, s94, 98304
    s_add_u32 s83, s93, 24576
    buffer_load_dwordx4 v252, s[12:15], s83 offen sc1 lds
    s_add_u32 m0, s94, 100352
    s_add_u32 s83, s93, 25600
    buffer_load_dwordx4 v252, s[12:15], s83 offen sc1 lds
    s_add_u32 m0, s94, 102400
    s_add_u32 s83, s93, 26624
    buffer_load_dwordx4 v252, s[12:15], s83 offen sc1 lds
    s_add_u32 m0, s94, 104448
    s_add_u32 s83, s93, 27648
    buffer_load_dwordx4 v252, s[12:15], s83 offen sc1 lds
    s_add_u32 m0, s94, 106496
    s_add_u32 s83, s93, 28672
    buffer_load_dwordx4 v252, s[12:15], s83 offen sc1 lds
    s_add_u32 m0, s94, 108544
    s_add_u32 s83, s93, 29696
    buffer_load_dwordx4 v252, s[12:15], s83 offen sc1 lds
    s_add_u32 m0, s94, 110592
    s_add_u32 s83, s93, 30720
    buffer_load_dwordx4 v252, s[12:15], s83 offen sc1 lds
    s_add_u32 m0, s94, 112640
    s_add_u32 s83, s93, 31744
    buffer_load_dwordx4 v252, s[12:15], s83 offen sc1 lds
    s_waitcnt vmcnt(16)
    s_barrier
    s_add_u32 m0, s94, 131072
    s_add_u32 s83, s93, 32768
    buffer_load_dwordx4 v252, s[12:15], s83 offen sc1 lds
    s_add_u32 m0, s94, 133120
    s_add_u32 s83, s93, 33792
    buffer_load_dwordx4 v252, s[12:15], s83 offen sc1 lds
    s_add_u32 m0, s94, 135168
    s_add_u32 s83, s93, 34816
    buffer_load_dwordx4 v252, s[12:15], s83 offen sc1 lds
    s_add_u32 m0, s94, 137216
    s_add_u32 s83, s93, 35840
    buffer_load_dwordx4 v252, s[12:15], s83 offen sc1 lds
    s_add_u32 m0, s94, 139264
    s_add_u32 s83, s93, 36864
    buffer_load_dwordx4 v252, s[12:15], s83 offen sc1 lds
    s_add_u32 m0, s94, 141312
    s_add_u32 s83, s93, 37888
    buffer_load_dwordx4 v252, s[12:15], s83 offen sc1 lds
    s_add_u32 m0, s94, 143360
    s_add_u32 s83, s93, 38912
    buffer_load_dwordx4 v252, s[12:15], s83 offen sc1 lds
    s_add_u32 m0, s94, 145408
    s_add_u32 s83, s93, 39936
    buffer_load_dwordx4 v252, s[12:15], s83 offen sc1 lds
    s_add_u32 m0, s94, 0
    s_add_u32 s83, s93, 40960
    buffer_load_dwordx4 v252, s[12:15], s83 offen sc1 lds
    s_add_u32 m0, s94, 2048
    s_add_u32 s83, s93, 41984
    buffer_load_dwordx4 v252, s[12:15], s83 offen sc1 lds
    s_add_u32 m0, s94, 4096
    s_add_u32 s83, s93, 43008
    buffer_load_dwordx4 v252, s[12:15], s83 offen sc1 lds
    s_waitcnt vmcnt(19)
    s_barrier
    s_waitcnt vmcnt(11)
    s_barrier
    s_waitcnt vmcnt(3)
    s_barrier
    s_waitcnt vmcnt(0)
    s_barrier
    s_branch L3_done
L3_hw_start:
    s_sub_u32 s77, s44, 4
    s_lshl_b32 s89, s89, 14
    s_lshl_b32 s78, s77, 11
    s_add_u32 s89, s89, s78
    s_add_u32 s89, s89, 18874368
    v_lshlrev_b32 v4, 4, v253
    s_add_u32 s80, s78, 155648
    v_add_u32 v4, s80, v4
    v_and_b32 v5, 15, v253
    v_cmp_eq_u32 vcc, 0, v5
    v_mov_b32 v6, 0x3f803f80
    s_nop 0
    v_cndmask_b32 v8, 0, v6, vcc
    v_mov_b32 v9, v8
    v_mov_b32 v10, v8
    v_mov_b32 v11, v8
    ds_write_b128 v4, v[8:11]
    ds_write_b128 v4, v[8:11] offset:1024
    v_and_b32 v2, 31, v253
    v_lshlrev_b32 v2, 2, v2
    s_mov_b32 s95, 0
L_poll_p1h:
    buffer_load_dword v3, v2, s[12:15], s85 offen sc1
    s_add_u32 s95, s95, 1
    s_waitcnt vmcnt(0)
    v_cmp_ne_u32 vcc, s45, v3
    s_cmp_gt_u32 s95, 0x100000
    s_cbranch_scc1 L_poll_p1h_x
    s_cbranch_vccnz L_poll_p1h
L_poll_p1h_x:
    s_add_u32 m0, s78, 0
    s_add_u32 s82, s89, 8192
    buffer_load_dwordx4 v252, s[12:15], s89 offen sc1 lds
    s_add_u32 m0, s78, 1024
    s_add_u32 s83, s89, 1024
    buffer_load_dwordx4 v252, s[12:15], s83 offen sc1 lds
    s_add_u32 m0, s78, 8192
    s_add_u32 s83, s82, 1024
    buffer_load_dwordx4 v252, s[12:15], s82 offen sc1 lds
    s_add_u32 m0, s78, 9216
    s_nop 0
    buffer_load_dwordx4 v252, s[12:15], s83 offen sc1 lds
    s_lshl_b32 s85, s43, 3
    s_add_u32 s85, s85, s44
    s_lshl_b32 s85, s85, 5
    s_lshl_b32 s86, s42, 2
    s_add_u32 s85, s85, s86
    s_add_u32 s85, s85, 4096
    v_mov_b32 v2, s45
    v_mov_b32 v3, 0
    s_mov_b64 exec, 1
    buffer_store_dword v2, v3, s[12:15], s85 offen sc1
    s_mov_b64 exec, -1
    s_lshl_b32 s76, s43, 17
    s_add_u32 s76, s76, 1048576
    s_add_u32 s76, s76, s78
    s_waitcnt vmcnt(1) lgkmcnt(0)
    s_barrier
    s_and_b32 s80, s43, 28
    s_add_u32 s80, s80, s77
    s_lshl_b32 s80, s80, 8
    s_add_u32 s79, s80, 4096
    v_bfe_u32 v4, v253, 4, 1
    v_bfe_u32 v5, v253, 3, 1
    s_and_b32 s81, s43, 3
    s_and_b32 s82, s43, 2
    v_lshlrev_b32 v6, 2, v4
    v_add_u32 v7, s81, v6
    v_add_u32 v6, s82, v6
    v_add_u32 v6, v6, v4
    v_cmp_eq_u32 vcc, 0, v5
    v_and_b32 v2, 7, v253
    v_lshlrev_b32 v2, 2, v2
    v_cndmask_b32 v6, v6, v7, vcc
    v_lshl_add_u32 v2, v6, 5, v2
    s_mov_b32 s95, 0
L_poll_kv3:
    buffer_load_dword v3, v2, s[12:15], s79 offen sc1
    s_add_u32 s95, s95, 1
    s_waitcnt vmcnt(0)
    v_cmp_ne_u32 vcc, s45, v3
    s_cmp_gt_u32 s95, 0x100000
    s_cbranch_scc1 L_poll_kv3_x
    s_cbranch_vccnz L_poll_kv3
L_poll_kv3_x:
    s_add_u32 s80, s42, 1
    s_and_b32 s80, s80, 7
    s_lshl_b32 s80, s80, 14
    s_add_u32 s80, s80, s76
    s_add_u32 m0, s78, 16384
    s_add_u32 s82, s80, 8192
    buffer_load_dwordx4 v252, s[12:15], s80 offen sc1 lds
    s_add_u32 m0, s78, 17408
    s_add_u32 s83, s80, 1024
    buffer_load_dwordx4 v252, s[12:15], s83 offen sc1 lds
    s_add_u32 m0, s78, 24576
    s_add_u32 s83, s82, 1024
    buffer_load_dwordx4 v252, s[12:15], s82 offen sc1 lds
    s_add_u32 m0, s78, 25600
    s_nop 0
    buffer_load_dwordx4 v252, s[12:15], s83 offen sc1 lds
    s_add_u32 s80, s42, 2
    s_and_b32 s80, s80, 7
    s_lshl_b32 s80, s80, 14
    s_add_u32 s80, s80, s76
    s_add_u32 m0, s78, 32768
    s_add_u32 s82, s80, 8192
    buffer_load_dwordx4 v252, s[12:15], s80 offen sc1 lds
    s_add_u32 m0, s78, 33792
    s_add_u32 s83, s80, 1024
    buffer_load_dwordx4 v252, s[12:15], s83 offen sc1 lds
    s_add_u32 m0, s78, 40960
    s_add_u32 s83, s82, 1024
    buffer_load_dwordx4 v252, s[12:15], s82 offen sc1 lds
    s_add_u32 m0, s78, 41984
    s_nop 0
    buffer_load_dwordx4 v252, s[12:15], s83 offen sc1 lds
    s_add_u32 s80, s42, 3
    s_and_b32 s80, s80, 7
    s_lshl_b32 s80, s80, 14
    s_add_u32 s80, s80, s76
    s_add_u32 m0, s78, 49152
    s_add_u32 s82, s80, 8192
    buffer_load_dwordx4 v252, s[12:15], s80 offen sc1 lds
    s_add_u32 m0, s78, 50176
    s_add_u32 s83, s80, 1024
    buffer_load_dwordx4 v252, s[12:15], s83 offen sc1 lds
    s_add_u32 m0, s78, 57344
    s_add_u32 s83, s82, 1024
    buffer_load_dwordx4 v252, s[12:15], s82 offen sc1 lds
    s_add_u32 m0, s78, 58368
    s_nop 0
    buffer_load_dwordx4 v252, s[12:15], s83 offen sc1 lds
    s_and_b32 s86, s77, 1
    s_mul_i32 s86, s86, 704512
    s_and_b32 s80, s43, 7
    s_lshl_b32 s80, s80, 7
    s_add_u32 s86, s86, s80
    s_lshr_b32 s80, s77, 1
    s_lshl_b32 s80, s80, 6
    s_add_u32 s86, s86, s80
    s_mul_i32 s87, s77, 6144
    s_add_u32 s87, s87, 131072
    v_lshrrev_b32 v13, 2, v253
    v_lshlrev_b32 v12, 10, v13
    v_and_b32 v13, 3, v253
    v_lshl_add_u32 v12, v13, 4, v12
    v_lshrrev_b32 v14, 5, v253
    v_bfe_u32 v15, v253, 2, 2
    v_lshl_add_u32 v14, v14, 2, v15
    v_lshlrev_b32 v13, 6, v14
    v_bfe_u32 v15, v253, 4, 1
    v_lshl_add_u32 v13, v15, 5, v13
    v_and_b32 v15, 3, v253
    v_lshl_add_u32 v13, v15, 3, v13
    v_add_u32 v13, s87, v13
    s_waitcnt vmcnt(8)
    s_barrier
    s_add_u32 s80, s42, 4
    s_and_b32 s80, s80, 7
    s_lshl_b32 s80, s80, 14
    s_add_u32 s80, s80, s76
    s_add_u32 m0, s78, 65536
    s_add_u32 s82, s80, 8192
    buffer_load_dwordx4 v252, s[12:15], s80 offen sc1 lds
    s_add_u32 m0, s78, 66560
    s_add_u32 s83, s80, 1024
    buffer_load_dwordx4 v252, s[12:15], s83 offen sc1 lds
    s_add_u32 m0, s78, 73728
    s_add_u32 s83, s82, 1024
    buffer_load_dwordx4 v252, s[12:15], s82 offen sc1 lds
    s_add_u32 m0, s78, 74752
    s_nop 0
    buffer_load_dwordx4 v252, s[12:15], s83 offen sc1 lds
    s_waitcnt vmcnt(8)
    s_barrier
    s_add_u32 s80, s42, 5
    s_and_b32 s80, s80, 7
    s_lshl_b32 s80, s80, 14
    s_add_u32 s80, s80, s76
    s_add_u32 m0, s78, 81920
    s_add_u32 s82, s80, 8192
    buffer_load_dwordx4 v252, s[12:15], s80 offen sc1 lds
    s_add_u32 m0, s78, 82944
    s_add_u32 s83, s80, 1024
    buffer_load_dwordx4 v252, s[12:15], s83 offen sc1 lds
    s_add_u32 m0, s78, 90112
    s_add_u32 s83, s82, 1024
    buffer_load_dwordx4 v252, s[12:15], s82 offen sc1 lds
    s_add_u32 m0, s78, 91136
    s_nop 0
    buffer_load_dwordx4 v252, s[12:15], s83 offen sc1 lds
    s_and_b32 s80, s43, 7
    s_lshl_b32 s80, s80, 7
    s_lshr_b32 s81, s77, 1
    s_lshl_b32 s81, s81, 6
    s_add_u32 s80, s80, s81
    v_lshrrev_b32 v3, 5, v253
    v_lshlrev_b32 v3, 3, v3
    buffer_load_dwordx2 v[72:73], v3, s[36:39], s80 offen offset:0
    buffer_load_dwordx2 v[74:75], v3, s[36:39], s80 offen offset:16
    buffer_load_dwordx2 v[76:77], v3, s[36:39], s80 offen offset:32
    buffer_load_dwordx2 v[78:79], v3, s[36:39], s80 offen offset:48
    s_and_b32 s80, s43, 15
    s_mul_i32 s80, s80, 174768
    s_lshr_b32 s80, s80, 16
    s_lshl_b32 s80, s80, 6
    v_lshlrev_b32 v2, 2, v253
    buffer_load_dword v71, v2, s[32:35], s80 offen
    s_waitcnt vmcnt(13)
    s_barrier
    s_add_u32 s80, s42, 6
    s_and_b32 s80, s80, 7
    s_lshl_b32 s80, s80, 14
    s_add_u32 s80, s80, s76
    s_add_u32 m0, s78, 98304
    s_add_u32 s82, s80, 8192
    buffer_load_dwordx4 v252, s[12:15], s80 offen sc1 lds
    s_add_u32 m0, s78, 99328
    s_add_u32 s83, s80, 1024
    buffer_load_dwordx4 v252, s[12:15], s83 offen sc1 lds
    s_add_u32 m0, s78, 106496
    s_add_u32 s83, s82, 1024
    buffer_load_dwordx4 v252, s[12:15], s82 offen sc1 lds
    s_add_u32 m0, s78, 107520
    s_nop 0
    buffer_load_dwordx4 v252, s[12:15], s83 offen sc1 lds
    s_lshl_b32 s80, s43, 2
    s_add_u32 s80, s80, s77
    s_mul_i32 s81, s80, 11008
    s_and_b32 s81, s81, 0xffffff80
    s_add_u32 s81, s81, 0
    buffer_load_dwordx4 v[8:11], v252, s[24:27], s81 offen
    s_lshl_b32 s80, s43, 2
    s_add_u32 s80, s80, s77
    s_mul_i32 s81, s80, 11008
    s_and_b32 s81, s81, 0xffffff80
    s_add_u32 s81, s81, 1024
    buffer_load_dwordx4 v[8:11], v252, s[24:27], s81 offen
    s_lshl_b32 s80, s43, 2
    s_add_u32 s80, s80, s77
    s_mul_i32 s81, s80, 11008
    s_and_b32 s81, s81, 0xffffff80
    s_add_u32 s81, s81, 2048
    buffer_load_dwordx4 v[8:11], v252, s[24:27], s81 offen
    s_lshl_b32 s80, s43, 2
    s_add_u32 s80, s80, s77
    s_mul_i32 s81, s80, 11008
    s_and_b32 s81, s81, 0xffffff80
    s_add_u32 s81, s81, 3072
    buffer_load_dwordx4 v[8:11], v252, s[24:27], s81 offen
    s_lshl_b32 s80, s43, 2
    s_add_u32 s80, s80, s77
    s_mul_i32 s81, s80, 11008
    s_and_b32 s81, s81, 0xffffff80
    s_add_u32 s81, s81, 4096
    buffer_load_dwordx4 v[8:11], v252, s[24:27], s81 offen
    s_lshl_b32 s80, s43, 2
    s_add_u32 s80, s80, s77
    s_mul_i32 s81, s80, 11008
    s_and_b32 s81, s81, 0xffffff80
    s_add_u32 s81, s81, 5120
    buffer_load_dwordx4 v[8:11], v252, s[24:27], s81 offen
    s_lshl_b32 s80, s43, 2
    s_add_u32 s80, s80, s77
    s_mul_i32 s81, s80, 11008
    s_and_b32 s81, s81, 0xffffff80
    s_add_u32 s81, s81, 6144
    buffer_load_dwordx4 v[8:11], v252, s[24:27], s81 offen
    s_lshl_b32 s80, s43, 2
    s_add_u32 s80, s80, s77
    s_mul_i32 s81, s80, 11008
    s_and_b32 s81, s81, 0xffffff80
    s_add_u32 s81, s81, 7168
    buffer_load_dwordx4 v[8:11], v252, s[24:27], s81 offen
    s_lshl_b32 s80, s43, 2
    s_add_u32 s80, s80, s77
    s_mul_i32 s81, s80, 11008
    s_and_b32 s81, s81, 0xffffff80
    s_add_u32 s81, s81, 8192
    buffer_load_dwordx4 v[8:11], v252, s[24:27], s81 offen
    s_lshl_b32 s80, s43, 2
    s_add_u32 s80, s80, s77
    s_mul_i32 s81, s80, 11008
    s_and_b32 s81, s81, 0xffffff80
    s_add_u32 s81, s81, 9216
    buffer_load_dwordx4 v[8:11], v252, s[24:27], s81 offen
    s_lshl_b32 s80, s43, 2
    s_add_u32 s80, s80, s77
    s_mul_i32 s81, s80, 11008
    s_and_b32 s81, s81, 0xffffff80
    s_add_u32 s81, s81, 10240
    buffer_load_dwordx4 v[8:11], v252, s[24:27], s81 offen
    s_waitcnt vmcnt(24)
    s_barrier
    s_add_u32 m0, s87, 0
    s_add_u32 s80, s86, 0
    buffer_load_dwordx4 v12, s[24:27], s80 offen lds
    s_add_u32 m0, s87, 1024
    s_add_u32 s80, s86, 16384
    buffer_load_dwordx4 v12, s[24:27], s80 offen lds
    s_add_u32 m0, s87, 2048
    s_add_u32 s80, s86, 32768
    buffer_load_dwordx4 v12, s[24:27], s80 offen lds
    s_add_u32 m0, s87, 3072
    s_add_u32 s80, s86, 49152
    buffer_load_dwordx4 v12, s[24:27], s80 offen lds
    s_add_u32 m0, s87, 4096
    s_add_u32 s80, s86, 65536
    buffer_load_dwordx4 v12, s[24:27], s80 offen lds
    s_add_u32 m0, s87, 5120
    s_add_u32 s80, s86, 81920
    buffer_load_dwordx4 v12, s[24:27], s80 offen lds
    s_add_u32 s80, s42, 7
    s_and_b32 s80, s80, 7
    s_lshl_b32 s80, s80, 14
    s_add_u32 s80, s80, s76
    s_add_u32 m0, s78, 114688
    s_add_u32 s82, s80, 8192
    buffer_load_dwordx4 v252, s[12:15], s80 offen sc1 lds
    s_add_u32 m0, s78, 115712
    s_add_u32 s83, s80, 1024
    buffer_load_dwordx4 v252, s[12:15], s83 offen sc1 lds
    s_add_u32 m0, s78, 122880
    s_add_u32 s83, s82, 1024
    buffer_load_dwordx4 v252, s[12:15], s82 offen sc1 lds
    s_add_u32 m0, s78, 123904
    s_nop 0
    buffer_load_dwordx4 v252, s[12:15], s83 offen sc1 lds
    s_waitcnt vmcnt(4)
    ds_read_b64_tr_b16 v[80:81], v13 offset:0
    ds_read_b64_tr_b16 v[82:83], v13 offset:512
    ds_read_b64_tr_b16 v[84:85], v13 offset:1024
    ds_read_b64_tr_b16 v[86:87], v13 offset:1536
    ds_read_b64_tr_b16 v[88:89], v13 offset:2048
    ds_read_b64_tr_b16 v[90:91], v13 offset:2560
    ds_read_b64_tr_b16 v[92:93], v13 offset:3072
    ds_read_b64_tr_b16 v[94:95], v13 offset:3584
    ds_read_b64_tr_b16 v[96:97], v13 offset:4096
    ds_read_b64_tr_b16 v[98:99], v13 offset:4608
    ds_read_b64_tr_b16 v[100:101], v13 offset:5120
    ds_read_b64_tr_b16 v[102:103], v13 offset:5632
    s_waitcnt lgkmcnt(0)
    s_add_u32 m0, s87, 0
    s_add_u32 s80, s86, 98304
    buffer_load_dwordx4 v12, s[24:27], s80 offen lds
    s_add_u32 m0, s87, 1024
    s_add_u32 s80, s86, 114688
    buffer_load_dwordx4 v12, s[24:27], s80 offen lds
    s_add_u32 m0, s87, 2048
    s_add_u32 s80, s86, 131072
    buffer_load_dwordx4 v12, s[24:27], s80 offen lds
    s_add_u32 m0, s87, 3072
    s_add_u32 s80, s86, 147456
    buffer_load_dwordx4 v12, s[24:27], s80 offen lds
    s_add_u32 m0, s87, 4096
    s_add_u32 s80, s86, 163840
    buffer_load_dwordx4 v12, s[24:27], s80 offen lds
    s_add_u32 m0, s87, 5120
    s_add_u32 s80, s86, 180224
    buffer_load_dwordx4 v12, s[24:27], s80 offen lds
    s_waitcnt vmcnt(36)
    s_barrier
    s_waitcnt vmcnt(0)
    ds_read_b64_tr_b16 v[104:105], v13 offset:0
    ds_read_b64_tr_b16 v[106:107], v13 offset:512
    ds_read_b64_tr_b16 v[108:109], v13 offset:1024
    ds_read_b64_tr_b16 v[110:111], v13 offset:1536
    ds_read_b64_tr_b16 v[112:113], v13 offset:2048
    ds_read_b64_tr_b16 v[114:115], v13 offset:2560
    ds_read_b64_tr_b16 v[116:117], v13 offset:3072
    ds_read_b64_tr_b16 v[118:119], v13 offset:3584
    ds_read_b64_tr_b16 v[120:121], v13 offset:4096
    ds_read_b64_tr_b16 v[122:123], v13 offset:4608
    ds_read_b64_tr_b16 v[124:125], v13 offset:5120
    ds_read_b64_tr_b16 v[126:127], v13 offset:5632
    s_waitcnt lgkmcnt(0)
    s_add_u32 m0, s87, 0
    s_add_u32 s80, s86, 196608
    buffer_load_dwordx4 v12, s[24:27], s80 offen lds
    s_add_u32 m0, s87, 1024
    s_add_u32 s80, s86, 212992
    buffer_load_dwordx4 v12, s[24:27], s80 offen lds
    s_add_u32 m0, s87, 2048
    s_add_u32 s80, s86, 229376
    buffer_load_dwordx4 v12, s[24:27], s80 offen lds
    s_add_u32 m0, s87, 3072
    s_add_u32 s80, s86, 245760
    buffer_load_dwordx4 v12, s[24:27], s80 offen lds
    s_add_u32 m0, s87, 4096
    s_add_u32 s80, s86, 262144
    buffer_load_dwordx4 v12, s[24:27], s80 offen lds
    s_add_u32 m0, s87, 5120
    s_add_u32 s80, s86, 278528
    buffer_load_dwordx4 v12, s[24:27], s80 offen lds
    s_waitcnt vmcnt(0)
    ds_read_b64_tr_b16 v[128:129], v13 offset:0
    ds_read_b64_tr_b16 v[130:131], v13 offset:512
    ds_read_b64_tr_b16 v[132:133], v13 offset:1024
    ds_read_b64_tr_b16 v[134:135], v13 offset:1536
    ds_read_b64_tr_b16 v[136:137], v13 offset:2048
    ds_read_b64_tr_b16 v[138:139], v13 offset:2560
    ds_read_b64_tr_b16 v[140:141], v13 offset:3072
    ds_read_b64_tr_b16 v[142:143], v13 offset:3584
    ds_read_b64_tr_b16 v[144:145], v13 offset:4096
    ds_read_b64_tr_b16 v[146:147], v13 offset:4608
    ds_read_b64_tr_b16 v[148:149], v13 offset:5120
    ds_read_b64_tr_b16 v[150:151], v13 offset:5632
    s_waitcnt lgkmcnt(0)
    s_add_u32 m0, s87, 0
    s_add_u32 s80, s86, 294912
    buffer_load_dwordx4 v12, s[24:27], s80 offen lds
    s_add_u32 m0, s87, 1024
    s_add_u32 s80, s86, 311296
    buffer_load_dwordx4 v12, s[24:27], s80 offen lds
    s_add_u32 m0, s87, 2048
    s_add_u32 s80, s86, 327680
    buffer_load_dwordx4 v12, s[24:27], s80 offen lds
    s_add_u32 m0, s87, 3072
    s_add_u32 s80, s86, 344064
    buffer_load_dwordx4 v12, s[24:27], s80 offen lds
    s_add_u32 m0, s87, 4096
    s_add_u32 s80, s86, 360448
    buffer_load_dwordx4 v12, s[24:27], s80 offen lds
    s_add_u32 m0, s87, 5120
    s_add_u32 s80, s86, 376832
    buffer_load_dwordx4 v12, s[24:27], s80 offen lds
    s_lshl_b32 s80, s43, 2
    s_add_u32 s80, s80, s77
    s_mul_i32 s81, s80, 11008
    s_and_b32 s81, s81, 0xffffff80
    s_add_u32 s81, s81, 0
    buffer_load_dwordx4 v[8:11], v252, s[20:23], s81 offen
    s_lshl_b32 s80, s43, 2
    s_add_u32 s80, s80, s77
    s_mul_i32 s81, s80, 11008
    s_and_b32 s81, s81, 0xffffff80
    s_add_u32 s81, s81, 1024
    buffer_load_dwordx4 v[8:11], v252, s[20:23], s81 offen
    s_lshl_b32 s80, s43, 2
    s_add_u32 s80, s80, s77
    s_mul_i32 s81, s80, 11008
    s_and_b32 s81, s81, 0xffffff80
    s_add_u32 s81, s81, 2048
    buffer_load_dwordx4 v[8:11], v252, s[20:23], s81 offen
    s_lshl_b32 s80, s43, 2
    s_add_u32 s80, s80, s77
    s_mul_i32 s81, s80, 11008
    s_and_b32 s81, s81, 0xffffff80
    s_add_u32 s81, s81, 3072
    buffer_load_dwordx4 v[8:11], v252, s[20:23], s81 offen
    s_lshl_b32 s80, s43, 2
    s_add_u32 s80, s80, s77
    s_mul_i32 s81, s80, 11008
    s_and_b32 s81, s81, 0xffffff80
    s_add_u32 s81, s81, 4096
    buffer_load_dwordx4 v[8:11], v252, s[20:23], s81 offen
    s_lshl_b32 s80, s43, 2
    s_add_u32 s80, s80, s77
    s_mul_i32 s81, s80, 11008
    s_and_b32 s81, s81, 0xffffff80
    s_add_u32 s81, s81, 5120
    buffer_load_dwordx4 v[8:11], v252, s[20:23], s81 offen
    s_lshl_b32 s80, s43, 2
    s_add_u32 s80, s80, s77
    s_mul_i32 s81, s80, 11008
    s_and_b32 s81, s81, 0xffffff80
    s_add_u32 s81, s81, 6144
    buffer_load_dwordx4 v[8:11], v252, s[20:23], s81 offen
    s_lshl_b32 s80, s43, 2
    s_add_u32 s80, s80, s77
    s_mul_i32 s81, s80, 11008
    s_and_b32 s81, s81, 0xffffff80
    s_add_u32 s81, s81, 7168
    buffer_load_dwordx4 v[8:11], v252, s[20:23], s81 offen
    s_lshl_b32 s80, s43, 2
    s_add_u32 s80, s80, s77
    s_mul_i32 s81, s80, 11008
    s_and_b32 s81, s81, 0xffffff80
    s_add_u32 s81, s81, 8192
    buffer_load_dwordx4 v[8:11], v252, s[20:23], s81 offen
    s_lshl_b32 s80, s43, 2
    s_add_u32 s80, s80, s77
    s_mul_i32 s81, s80, 11008
    s_and_b32 s81, s81, 0xffffff80
    s_add_u32 s81, s81, 9216
    buffer_load_dwordx4 v[8:11], v252, s[20:23], s81 offen
    s_lshl_b32 s80, s43, 2
    s_add_u32 s80, s80, s77
    s_mul_i32 s81, s80, 11008
    s_and_b32 s81, s81, 0xffffff80
    s_add_u32 s81, s81, 10240
    buffer_load_dwordx4 v[8:11], v252, s[20:23], s81 offen
    s_waitcnt vmcnt(50)
    s_barrier
    s_waitcnt vmcnt(11)
    ds_read_b64_tr_b16 v[152:153], v13 offset:0
    ds_read_b64_tr_b16 v[154:155], v13 offset:512
    ds_read_b64_tr_b16 v[156:157], v13 offset:1024
    ds_read_b64_tr_b16 v[158:159], v13 offset:1536
    ds_read_b64_tr_b16 v[160:161], v13 offset:2048
    ds_read_b64_tr_b16 v[162:163], v13 offset:2560
    ds_read_b64_tr_b16 v[164:165], v13 offset:3072
    ds_read_b64_tr_b16 v[166:167], v13 offset:3584
    ds_read_b64_tr_b16 v[168:169], v13 offset:4096
    ds_read_b64_tr_b16 v[170:171], v13 offset:4608
    ds_read_b64_tr_b16 v[172:173], v13 offset:5120
    ds_read_b64_tr_b16 v[174:175], v13 offset:5632
    s_waitcnt lgkmcnt(0)
    s_add_u32 m0, s87, 0
    s_add_u32 s80, s86, 393216
    buffer_load_dwordx4 v12, s[24:27], s80 offen lds
    s_add_u32 m0, s87, 1024
    s_add_u32 s80, s86, 409600
    buffer_load_dwordx4 v12, s[24:27], s80 offen lds
    s_add_u32 m0, s87, 2048
    s_add_u32 s80, s86, 425984
    buffer_load_dwordx4 v12, s[24:27], s80 offen lds
    s_add_u32 m0, s87, 3072
    s_add_u32 s80, s86, 442368
    buffer_load_dwordx4 v12, s[24:27], s80 offen lds
    s_add_u32 m0, s87, 4096
    s_add_u32 s80, s86, 458752
    buffer_load_dwordx4 v12, s[24:27], s80 offen lds
    s_add_u32 m0, s87, 5120
    s_add_u32 s80, s86, 475136
    buffer_load_dwordx4 v12, s[24:27], s80 offen lds
    s_waitcnt vmcnt(0)
    ds_read_b64_tr_b16 v[176:177], v13 offset:0
    ds_read_b64_tr_b16 v[178:179], v13 offset:512
    ds_read_b64_tr_b16 v[180:181], v13 offset:1024
    ds_read_b64_tr_b16 v[182:183], v13 offset:1536
    ds_read_b64_tr_b16 v[184:185], v13 offset:2048
    ds_read_b64_tr_b16 v[186:187], v13 offset:2560
    ds_read_b64_tr_b16 v[188:189], v13 offset:3072
    ds_read_b64_tr_b16 v[190:191], v13 offset:3584
    ds_read_b64_tr_b16 v[192:193], v13 offset:4096
    ds_read_b64_tr_b16 v[194:195], v13 offset:4608
    ds_read_b64_tr_b16 v[196:197], v13 offset:5120
    ds_read_b64_tr_b16 v[198:199], v13 offset:5632
    s_waitcnt lgkmcnt(0)
    s_add_u32 m0, s87, 0
    s_add_u32 s80, s86, 491520
    buffer_load_dwordx4 v12, s[24:27], s80 offen lds
    s_add_u32 m0, s87, 1024
    s_add_u32 s80, s86, 507904
    buffer_load_dwordx4 v12, s[24:27], s80 offen lds
    s_add_u32 m0, s87, 2048
    s_add_u32 s80, s86, 524288
    buffer_load_dwordx4 v12, s[24:27], s80 offen lds
    s_add_u32 m0, s87, 3072
    s_add_u32 s80, s86, 540672
    buffer_load_dwordx4 v12, s[24:27], s80 offen lds
    s_add_u32 m0, s87, 4096
    s_add_u32 s80, s86, 557056
    buffer_load_dwordx4 v12, s[24:27], s80 offen lds
    s_add_u32 m0, s87, 5120
    s_add_u32 s80, s86, 573440
    buffer_load_dwordx4 v12, s[24:27], s80 offen lds
    s_lshl_b32 s80, s43, 2
    s_add_u32 s80, s80, s77
    s_lshl_b32 s81, s80, 12
    s_add_u32 s81, s81, 0
    buffer_load_dwordx4 v[8:11], v252, s[16:19], s81 offen
    s_lshl_b32 s80, s43, 2
    s_add_u32 s80, s80, s77
    s_lshl_b32 s81, s80, 12
    s_add_u32 s81, s81, 1024
    buffer_load_dwordx4 v[8:11], v252, s[16:19], s81 offen
    s_lshl_b32 s80, s43, 2
    s_add_u32 s80, s80, s77
    s_lshl_b32 s81, s80, 12
    s_add_u32 s81, s81, 2048
    buffer_load_dwordx4 v[8:11], v252, s[16:19], s81 offen
    s_lshl_b32 s80, s43, 2
    s_add_u32 s80, s80, s77
    s_lshl_b32 s81, s80, 12
    s_add_u32 s81, s81, 3072
    buffer_load_dwordx4 v[8:11], v252, s[16:19], s81 offen
    s_lshl_b32 s80, s43, 3
    s_lshl_b32 s81, s77, 1
    s_add_u32 s80, s80, s81
    s_add_u32 s80, s80, 0
    s_lshl_b32 s81, s42, 18
    s_lshl_b32 s82, s80, 10
    s_add_u32 s81, s81, s82
    s_add_u32 s82, s81, 5242880
    buffer_load_dwordx4 v[8:11], v252, s[12:15], s82 offen
    s_add_u32 s82, s81, 7340032
    buffer_load_dwordx4 v[8:11], v252, s[12:15], s82 offen
    s_mul_i32 s81, s42, 704512
    s_mul_i32 s82, s80, 2752
    s_and_b32 s82, s82, 0xffffff80
    s_add_u32 s81, s81, s82
    s_add_u32 s81, s81, 9437184
    buffer_load_dwordx4 v[8:11], v252, s[12:15], s81 offen offset:0
    buffer_load_dwordx4 v[8:11], v252, s[12:15], s81 offen offset:1024
    buffer_load_dwordx4 v[8:11], v252, s[12:15], s81 offen offset:2048
    s_lshl_b32 s81, s42, 15
    s_lshl_b32 s82, s80, 7
    s_add_u32 s81, s81, s82
    s_add_u32 s81, s81, 15204352
    s_mov_b64 exec, 0xff
    buffer_load_dwordx4 v[8:11], v252, s[12:15], s81 offen
    s_mov_b64 exec, -1
    s_lshl_b32 s80, s43, 3
    s_lshl_b32 s81, s77, 1
    s_add_u32 s80, s80, s81
    s_add_u32 s80, s80, 1
    s_lshl_b32 s81, s42, 18
    s_lshl_b32 s82, s80, 10
    s_add_u32 s81, s81, s82
    s_add_u32 s82, s81, 5242880
    buffer_load_dwordx4 v[8:11], v252, s[12:15], s82 offen
    s_add_u32 s82, s81, 7340032
    buffer_load_dwordx4 v[8:11], v252, s[12:15], s82 offen
    s_mul_i32 s81, s42, 704512
    s_mul_i32 s82, s80, 2752
    s_and_b32 s82, s82, 0xffffff80
    s_add_u32 s81, s81, s82
    s_add_u32 s81, s81, 9437184
    buffer_load_dwordx4 v[8:11], v252, s[12:15], s81 offen offset:0
    buffer_load_dwordx4 v[8:11], v252, s[12:15], s81 offen offset:1024
    buffer_load_dwordx4 v[8:11], v252, s[12:15], s81 offen offset:2048
    s_lshl_b32 s81, s42, 15
    s_lshl_b32 s82, s80, 7
    s_add_u32 s81, s81, s82
    s_add_u32 s81, s81, 15204352
    s_mov_b64 exec, 0xff
    buffer_load_dwordx4 v[8:11], v252, s[12:15], s81 offen
    s_mov_b64 exec, -1
    s_waitcnt vmcnt(57)
    s_barrier
    s_waitcnt vmcnt(16)
    ds_read_b64_tr_b16 v[200:201], v13 offset:0
    ds_read_b64_tr_b16 v[202:203], v13 offset:512
    ds_read_b64_tr_b16 v[204:205], v13 offset:1024
    ds_read_b64_tr_b16 v[206:207], v13 offset:1536
    ds_read_b64_tr_b16 v[208:209], v13 offset:2048
    ds_read_b64_tr_b16 v[210:211], v13 offset:2560
    ds_read_b64_tr_b16 v[212:213], v13 offset:3072
    ds_read_b64_tr_b16 v[214:215], v13 offset:3584
    ds_read_b64_tr_b16 v[216:217], v13 offset:4096
    ds_read_b64_tr_b16 v[218:219], v13 offset:4608
    ds_read_b64_tr_b16 v[220:221], v13 offset:5120
    ds_read_b64_tr_b16 v[222:223], v13 offset:5632
    s_waitcnt lgkmcnt(0)
    s_add_u32 m0, s87, 0
    s_add_u32 s80, s86, 589824
    buffer_load_dwordx4 v12, s[24:27], s80 offen lds
    s_add_u32 m0, s87, 1024
    s_add_u32 s80, s86, 606208
    buffer_load_dwordx4 v12, s[24:27], s80 offen lds
    s_add_u32 m0, s87, 2048
    s_add_u32 s80, s86, 622592
    buffer_load_dwordx4 v12, s[24:27], s80 offen lds
    s_add_u32 m0, s87, 3072
    s_add_u32 s80, s86, 638976
    buffer_load_dwordx4 v12, s[24:27], s80 offen lds
    s_add_u32 m0, s87, 4096
    s_add_u32 s80, s86, 655360
    buffer_load_dwordx4 v12, s[24:27], s80 offen lds
    s_add_u32 m0, s87, 5120
    s_add_u32 s80, s86, 671744
    buffer_load_dwordx4 v12, s[24:27], s80 offen lds
    s_waitcnt vmcnt(0)
    ds_read_b64_tr_b16 v[224:225], v13 offset:0
    ds_read_b64_tr_b16 v[226:227], v13 offset:512
    ds_read_b64_tr_b16 v[228:229], v13 offset:1024
    ds_read_b64_tr_b16 v[230:231], v13 offset:1536
    ds_read_b64_tr_b16 v[232:233], v13 offset:2048
    ds_read_b64_tr_b16 v[234:235], v13 offset:2560
    ds_read_b64_tr_b16 v[236:237], v13 offset:3072
    ds_read_b64_tr_b16 v[238:239], v13 offset:3584
    ds_read_b64_tr_b16 v[240:241], v13 offset:4096
    ds_read_b64_tr_b16 v[242:243], v13 offset:4608
    ds_read_b64_tr_b16 v[244:245], v13 offset:5120
    ds_read_b64_tr_b16 v[246:247], v13 offset:5632
    s_waitcnt lgkmcnt(0)
    s_add_u32 m0, s87, 0
    s_add_u32 s80, s86, 688128
    buffer_load_dwordx4 v12, s[24:27], s80 offen lds
    s_barrier
    s_waitcnt vmcnt(0)
    ds_read_b64_tr_b16 v[248:249], v13 offset:0
    ds_read_b64_tr_b16 v[250:251], v13 offset:512
    s_waitcnt lgkmcnt(0)
    s_barrier
    s_lshr_b32 s100, s43, 3
    s_and_b32 s101, s43, 7
    s_lshr_b32 s3, s43, 4
    s_and_b32 s80, s43, 15
    s_mul_i32 s80, s80, 174768
    s_lshr_b32 s51, s80, 16
    s_cmp_lg_u32 s77, 0
    s_cbranch_scc1 L3_nf_o
    s_lshl_b32 s80, s42, 7
    s_add_u32 s80, s80, 67584
    s_lshl_b32 s81, s43, 2
    s_add_u32 s81, s81, s80
    v_mov_b32 v2, s45
    v_mov_b32 v3, 0
    s_mov_b64 exec, 1
    s_cmp_eq_u32 s46, 0
    s_cbranch_scc1 L_tf_o3_s
    buffer_store_dword v2, v3, s[12:15], s81 offen
    s_branch L_tf_o3_d
L_tf_o3_s:
    buffer_store_dword v2, v3, s[12:15], s81 offen sc1
L_tf_o3_d:
    s_mov_b64 exec, -1
L3_nf_o:
    v_lshrrev_b32 v10, 3, v253
    v_lshlrev_b32 v10, 10, v10
    v_bfe_u32 v11, v253, 4, 1
    v_lshlrev_b32 v11, 1, v11
    v_bfe_u32 v9, v253, 1, 2
    v_xor_b32 v9, v9, v11
    v_lshl_add_u32 v10, v9, 5, v10
    v_and_b32 v9, 1, v253
    v_lshl_add_u32 v10, v9, 4, v10
    s_lshl_b32 s81, s77, 17
    s_lshl_b32 s82, s101, 7
    s_add_u32 s81, s81, s82
    s_lshl_b32 s82, s77, 14
    s_add_u32 m0, s82, 98304
    s_add_u32 s83, s81, 0
    buffer_load_dwordx4 v10, s[16:19], s83 offen lds
    s_add_u32 m0, s82, 99328
    s_add_u32 s83, s81, 8192
    buffer_load_dwordx4 v10, s[16:19], s83 offen lds
    s_add_u32 m0, s82, 100352
    s_add_u32 s83, s81, 16384
    buffer_load_dwordx4 v10, s[16:19], s83 offen lds
    s_add_u32 m0, s82, 101376
    s_add_u32 s83, s81, 24576
    buffer_load_dwordx4 v10, s[16:19], s83 offen lds
    s_add_u32 m0, s82, 102400
    s_add_u32 s83, s81, 32768
    buffer_load_dwordx4 v10, s[16:19], s83 offen lds
    s_add_u32 m0, s82, 103424
    s_add_u32 s83, s81, 40960
    buffer_load_dwordx4 v10, s[16:19], s83 offen lds
    s_add_u32 m0, s82, 104448
    s_add_u32 s83, s81, 49152
    buffer_load_dwordx4 v10, s[16:19], s83 offen lds
    s_add_u32 m0, s82, 105472
    s_add_u32 s83, s81, 57344
    buffer_load_dwordx4 v10, s[16:19], s83 offen lds
    s_add_u32 m0, s82, 106496
    s_add_u32 s83, s81, 65536
    buffer_load_dwordx4 v10, s[16:19], s83 offen lds
    s_add_u32 m0, s82, 107520
    s_add_u32 s83, s81, 73728
    buffer_load_dwordx4 v10, s[16:19], s83 offen lds
    s_add_u32 m0, s82, 108544
    s_add_u32 s83, s81, 81920
    buffer_load_dwordx4 v10, s[16:19], s83 offen lds
    s_add_u32 m0, s82, 109568
    s_add_u32 s83, s81, 90112
    buffer_load_dwordx4 v10, s[16:19], s83 offen lds
    s_add_u32 m0, s82, 110592
    s_add_u32 s83, s81, 98304
    buffer_load_dwordx4 v10, s[16:19], s83 offen lds
    s_add_u32 m0, s82, 111616
    s_add_u32 s83, s81, 106496
    buffer_load_dwordx4 v10, s[16:19], s83 offen lds
    s_add_u32 m0, s82, 112640
    s_add_u32 s83, s81, 114688
    buffer_load_dwordx4 v10, s[16:19], s83 offen lds
    s_add_u32 m0, s82, 113664
    s_add_u32 s83, s81, 122880
    buffer_load_dwordx4 v10, s[16:19], s83 offen lds
    s_mov_b32 s83, 0x1556
    v_mul_u32_u24 v47, s83, v253
    v_lshrrev_b32 v47, 16, v47
    v_mul_u32_u24 v46, 12, v47
    v_sub_u32 v46, v253, v46
    v_mul_u32_u24 v47, 2752, v47
    v_lshl_add_u32 v47, v46, 4, v47
    s_mul_i32 s93, s77, 13760
    s_lshl_b32 s82, s51, 6
    s_add_u32 s93, s93, s82
    s_mul_i32 s94, s77, 960
    s_waitcnt vmcnt(0)
    s_barrier
    s_lshl_b32 s81, s42, 3
    s_lshl_b32 s82, s100, 1
    s_add_u32 s81, s81, s82
    s_lshl_b32 s81, s81, 5
    s_lshl_b32 s82, s77, 1
    s_add_u32 s81, s81, s82
    s_lshl_b32 s81, s81, 10
    s_add_u32 s85, s81, 5242880
    s_lshl_b32 s86, s82, 10
    s_add_u32 s86, s86, 98304
    s_cmp_lg_u32 s77, 0
    s_cbranch_scc1 L3_o_np
    s_lshl_b32 s80, s42, 7
    s_add_u32 s80, s80, 67584
    v_and_b32 v2, 31, v253
    v_lshlrev_b32 v2, 2, v2
    s_mov_b32 s95, 0
L_poll_o3:
    buffer_load_dword v3, v2, s[12:15], s80 offen sc1
    s_add_u32 s95, s95, 1
    s_waitcnt vmcnt(0)
    v_cmp_ne_u32 vcc, s45, v3
    s_cmp_gt_u32 s95, 0x100000
    s_cbranch_scc1 L_poll_o3_x
    s_cbranch_vccnz L_poll_o3
L_poll_o3_x:
    s_branch L3_o_c
L3_o_np:
    s_add_u32 m0, s94, 0
    s_add_u32 s83, s93, 0
    buffer_load_dwordx4 v47, s[20:23], s83 offen lds
    s_add_u32 m0, s94, 3840
    s_add_u32 s83, s93, 55040
    buffer_load_dwordx4 v47, s[20:23], s83 offen lds
    s_add_u32 m0, s94, 7680
    s_add_u32 s83, s93, 110080
    buffer_load_dwordx4 v47, s[20:23], s83 offen lds
    s_add_u32 m0, s94, 11520
    s_add_u32 s83, s93, 165120
    buffer_load_dwordx4 v47, s[20:23], s83 offen lds
    s_add_u32 m0, s94, 15360
    s_add_u32 s83, s93, 220160
    buffer_load_dwordx4 v47, s[20:23], s83 offen lds
    s_add_u32 m0, s94, 19200
    s_add_u32 s83, s93, 275200
    buffer_load_dwordx4 v47, s[20:23], s83 offen lds
    s_add_u32 m0, s94, 23040
    s_add_u32 s83, s93, 330240
    buffer_load_dwordx4 v47, s[20:23], s83 offen lds
    s_add_u32 m0, s94, 26880
    s_add_u32 s83, s93, 385280
    buffer_load_dwordx4 v47, s[20:23], s83 offen lds
    s_add_u32 m0, s94, 30720
    s_add_u32 s83, s93, 440320
    buffer_load_dwordx4 v47, s[20:23], s83 offen lds
    s_add_u32 m0, s94, 34560
    s_add_u32 s83, s93, 495360
    buffer_load_dwordx4 v47, s[20:23], s83 offen lds
    s_add_u32 m0, s94, 38400
    s_add_u32 s83, s93, 550400
    buffer_load_dwordx4 v47, s[20:23], s83 offen lds
    s_add_u32 m0, s94, 42240
    s_add_u32 s83, s93, 605440
    buffer_load_dwordx4 v47, s[20:23], s83 offen lds
L3_o_c:
    s_barrier
    s_add_u32 m0, s86, 0
    s_add_u32 s83, s85, 0
    buffer_load_dwordx4 v252, s[12:15], s83 offen sc1 lds
    s_add_u32 m0, s86, 1024
    s_add_u32 s83, s85, 1024
    buffer_load_dwordx4 v252, s[12:15], s83 offen sc1 lds
    s_add_u32 m0, s86, 32768
    s_add_u32 s83, s85, 32768
    buffer_load_dwordx4 v252, s[12:15], s83 offen sc1 lds
    s_add_u32 m0, s86, 33792
    s_add_u32 s83, s85, 33792
    buffer_load_dwordx4 v252, s[12:15], s83 offen sc1 lds
    s_add_u32 m0, s86, 8192
    s_add_u32 s83, s85, 8192
    buffer_load_dwordx4 v252, s[12:15], s83 offen sc1 lds
    s_add_u32 m0, s86, 9216
    s_add_u32 s83, s85, 9216
    buffer_load_dwordx4 v252, s[12:15], s83 offen sc1 lds
    s_add_u32 m0, s86, 40960
    s_add_u32 s83, s85, 40960
    buffer_load_dwordx4 v252, s[12:15], s83 offen sc1 lds
    s_add_u32 m0, s86, 41984
    s_add_u32 s83, s85, 41984
    buffer_load_dwordx4 v252, s[12:15], s83 offen sc1 lds
    s_add_u32 m0, s86, 16384
    s_add_u32 s83, s85, 16384
    buffer_load_dwordx4 v252, s[12:15], s83 offen sc1 lds
    s_add_u32 m0, s86, 17408
    s_add_u32 s83, s85, 17408
    buffer_load_dwordx4 v252, s[12:15], s83 offen sc1 lds
    s_add_u32 m0, s86, 49152
    s_add_u32 s83, s85, 49152
    buffer_load_dwordx4 v252, s[12:15], s83 offen sc1 lds
    s_add_u32 m0, s86, 50176
    s_add_u32 s83, s85, 50176
    buffer_load_dwordx4 v252, s[12:15], s83 offen sc1 lds
    s_add_u32 m0, s86, 24576
    s_add_u32 s83, s85, 24576
    buffer_load_dwordx4 v252, s[12:15], s83 offen sc1 lds
    s_add_u32 m0, s86, 25600
    s_add_u32 s83, s85, 25600
    buffer_load_dwordx4 v252, s[12:15], s83 offen sc1 lds
    s_add_u32 m0, s86, 57344
    s_add_u32 s83, s85, 57344
    buffer_load_dwordx4 v252, s[12:15], s83 offen sc1 lds
    s_add_u32 m0, s86, 58368
    s_add_u32 s83, s85, 58368
    buffer_load_dwordx4 v252, s[12:15], s83 offen sc1 lds
    s_cmp_lg_u32 s77, 0
    s_cbranch_scc1 L3_o_w1b
    s_add_u32 m0, s94, 0
    s_add_u32 s83, s93, 0
    buffer_load_dwordx4 v47, s[20:23], s83 offen lds
    s_add_u32 m0, s94, 3840
    s_add_u32 s83, s93, 55040
    buffer_load_dwordx4 v47, s[20:23], s83 offen lds
    s_add_u32 m0, s94, 7680
    s_add_u32 s83, s93, 110080
    buffer_load_dwordx4 v47, s[20:23], s83 offen lds
    s_add_u32 m0, s94, 11520
    s_add_u32 s83, s93, 165120
    buffer_load_dwordx4 v47, s[20:23], s83 offen lds
    s_add_u32 m0, s94, 15360
    s_add_u32 s83, s93, 220160
    buffer_load_dwordx4 v47, s[20:23], s83 offen lds
    s_add_u32 m0, s94, 19200
    s_add_u32 s83, s93, 275200
    buffer_load_dwordx4 v47, s[20:23], s83 offen lds
    s_add_u32 m0, s94, 23040
    s_add_u32 s83, s93, 330240
    buffer_load_dwordx4 v47, s[20:23], s83 offen lds
    s_add_u32 m0, s94, 26880
    s_add_u32 s83, s93, 385280
    buffer_load_dwordx4 v47, s[20:23], s83 offen lds
    s_branch L3_o_w1c
L3_o_w1b:
    s_add_u32 m0, s94, 46080
    s_add_u32 s83, s93, 660480
    buffer_load_dwordx4 v47, s[20:23], s83 offen lds
    s_add_u32 m0, s94, 49920
    s_add_u32 s83, s93, 715520
    buffer_load_dwordx4 v47, s[20:23], s83 offen lds
    s_add_u32 m0, s94, 53760
    s_add_u32 s83, s93, 770560
    buffer_load_dwordx4 v47, s[20:23], s83 offen lds
    s_add_u32 m0, s94, 57600
    s_add_u32 s83, s93, 825600
    buffer_load_dwordx4 v47, s[20:23], s83 offen lds
    s_add_u32 m0, s94, 61440
    s_add_u32 s83, s93, 880640
    buffer_load_dwordx4 v47, s[20:23], s83 offen lds
    s_add_u32 m0, s94, 65280
    s_add_u32 s83, s93, 935680
    buffer_load_dwordx4 v47, s[20:23], s83 offen lds
    s_add_u32 m0, s94, 69120
    s_add_u32 s83, s93, 990720
    buffer_load_dwordx4 v47, s[20:23], s83 offen lds
    s_add_u32 m0, s94, 72960
    s_add_u32 s83, s93, 1045760
    buffer_load_dwordx4 v47, s[20:23], s83 offen lds
L3_o_w1c:
    s_waitcnt vmcnt(20)
    s_barrier
    s_waitcnt vmcnt(16)
    s_barrier
    s_waitcnt vmcnt(12)
    s_barrier
    s_waitcnt vmcnt(8)
    s_barrier
    s_cmp_lg_u32 s77, 0
    s_cbranch_scc1 L3_o_w1d
    s_add_u32 m0, s94, 30720
    s_add_u32 s83, s93, 440320
    buffer_load_dwordx4 v47, s[20:23], s83 offen lds
    s_add_u32 m0, s94, 34560
    s_add_u32 s83, s93, 495360
    buffer_load_dwordx4 v47, s[20:23], s83 offen lds
    s_add_u32 m0, s94, 38400
    s_add_u32 s83, s93, 550400
    buffer_load_dwordx4 v47, s[20:23], s83 offen lds
    s_add_u32 m0, s94, 42240
    s_add_u32 s83, s93, 605440
    buffer_load_dwordx4 v47, s[20:23], s83 offen lds
    s_add_u32 m0, s94, 46080
    s_add_u32 s83, s93, 660480
    buffer_load_dwordx4 v47, s[20:23], s83 offen lds
    s_add_u32 m0, s94, 49920
    s_add_u32 s83, s93, 715520
    buffer_load_dwordx4 v47, s[20:23], s83 offen lds
    s_add_u32 m0, s94, 53760
    s_add_u32 s83, s93, 770560
    buffer_load_dwordx4 v47, s[20:23], s83 offen lds
    s_add_u32 m0, s94, 57600
    s_add_u32 s83, s93, 825600
    buffer_load_dwordx4 v47, s[20:23], s83 offen lds
    s_add_u32 m0, s94, 61440
    s_add_u32 s83, s93, 880640
    buffer_load_dwordx4 v47, s[20:23], s83 offen lds
    s_add_u32 m0, s94, 65280
    s_add_u32 s83, s93, 935680
    buffer_load_dwordx4 v47, s[20:23], s83 offen lds
    s_add_u32 m0, s94, 69120
    s_add_u32 s83, s93, 990720
    buffer_load_dwordx4 v47, s[20:23], s83 offen lds
    s_add_u32 m0, s94, 72960
    s_add_u32 s83, s93, 1045760
    buffer_load_dwordx4 v47, s[20:23], s83 offen lds
    s_add_u32 m0, s94, 76800
    s_add_u32 s83, s93, 1100800
    buffer_load_dwordx4 v47, s[20:23], s83 offen lds
    s_add_u32 m0, s94, 80640
    s_add_u32 s83, s93, 1155840
    buffer_load_dwordx4 v47, s[20:23], s83 offen lds
    s_add_u32 m0, s94, 84480
    s_add_u32 s83, s93, 1210880
    buffer_load_dwordx4 v47, s[20:23], s83 offen lds
    s_add_u32 m0, s94, 88320
    s_add_u32 s83, s93, 1265920
    buffer_load_dwordx4 v47, s[20:23], s83 offen lds
    s_add_u32 m0, s94, 92160
    s_add_u32 s83, s93, 1320960
    buffer_load_dwordx4 v47, s[20:23], s83 offen lds
    s_cmp_eq_u32 s77, 3
    s_mov_b32 s84, 96000
    s_mov_b32 s83, 1376000
    s_cselect_b32 s84, 92160, s84
    s_cselect_b32 s83, 1320960, s83
    s_add_u32 m0, s94, s84
    s_add_u32 s83, s83, s93
    s_cmp_eq_u32 s77, 2
    s_cselect_b32 exec_lo, 0xffffff, -1
    s_cselect_b32 exec_hi, 0, -1
    buffer_load_dwordx4 v47, s[20:23], s83 offen lds
    s_mov_b64 exec, -1
    s_branch L3_o_w1e
L3_o_w1d:
    s_add_u32 m0, s94, 76800
    s_add_u32 s83, s93, 1100800
    buffer_load_dwordx4 v47, s[20:23], s83 offen lds
    s_add_u32 m0, s94, 80640
    s_add_u32 s83, s93, 1155840
    buffer_load_dwordx4 v47, s[20:23], s83 offen lds
    s_add_u32 m0, s94, 84480
    s_add_u32 s83, s93, 1210880
    buffer_load_dwordx4 v47, s[20:23], s83 offen lds
    s_add_u32 m0, s94, 88320
    s_add_u32 s83, s93, 1265920
    buffer_load_dwordx4 v47, s[20:23], s83 offen lds
    s_add_u32 m0, s94, 92160
    s_add_u32 s83, s93, 1320960
    buffer_load_dwordx4 v47, s[20:23], s83 offen lds
    s_cmp_eq_u32 s77, 3
    s_mov_b32 s84, 96000
    s_mov_b32 s83, 1376000
    s_cselect_b32 s84, 92160, s84
    s_cselect_b32 s83, 1320960, s83
    s_add_u32 m0, s94, s84
    s_add_u32 s83, s83, s93
    s_cmp_eq_u32 s77, 2
    s_cselect_b32 exec_lo, 0xffffff, -1
    s_cselect_b32 exec_hi, 0, -1
    buffer_load_dwordx4 v47, s[20:23], s83 offen lds
    s_mov_b64 exec, -1
L3_o_w1e:
    s_lshr_b32 s87, s77, 1
    s_and_b32 s88, s77, 1
    s_waitcnt vmcnt(0)
    s_barrier
    s_cmp_lg_u32 s77, 0
    s_cbranch_scc1 L3_h_cs
    s_lshl_b32 s80, s42, 7
    s_add_u32 s80, s80, 68608
    s_lshl_b32 s81, s43, 2
    s_add_u32 s81, s81, s80
    v_mov_b32 v2, s45
    v_mov_b32 v3, 0
    s_mov_b64 exec, 1
    s_cmp_eq_u32 s46, 0
    s_cbranch_scc1 L_tf_h3_s
    buffer_store_dword v2, v3, s[12:15], s81 offen
    s_branch L_tf_h3_d
L_tf_h3_s:
    buffer_store_dword v2, v3, s[12:15], s81 offen sc1
L_tf_h3_d:
    s_mov_b64 exec, -1
    v_lshlrev_b32 v8, 3, v253
    v_add_u32 v8, 147840, v8
    v_lshlrev_b32 v4, 16, v71
    v_and_b32 v5, 0xffff0000, v71
    v_cmp_gt_u32 vcc, 48, v253
    s_and_saveexec_b64 s[82:83], vcc
    ds_write_b64 v8, v[4:5]
    s_mov_b64 exec, -1
    s_lshl_b32 s80, s42, 7
    s_add_u32 s80, s80, 68608
    s_lshl_b32 s81, s3, 6
    s_add_u32 s80, s80, s81
    v_and_b32 v2, 15, v253
    v_lshlrev_b32 v2, 2, v2
    s_mov_b32 s95, 0
L_poll_h3:
    buffer_load_dword v3, v2, s[12:15], s80 offen sc1
    s_add_u32 s95, s95, 1
    s_waitcnt vmcnt(0)
    v_cmp_ne_u32 vcc, s45, v3
    s_cmp_gt_u32 s95, 0x100000
    s_cbranch_scc1 L_poll_h3_x
    s_cbranch_vccnz L_poll_h3
L_poll_h3_x:
    s_branch L3_h_j
L3_h_cs:
    v_lshrrev_b32 v11, 5, v253
    v_bfe_u32 v9, v253, 2, 2
    v_lshl_add_u32 v11, v11, 2, v9
    v_mul_u32_u24 v10, 192, v11
    v_bfe_u32 v9, v253, 4, 1
    v_lshl_add_u32 v10, v9, 5, v10
    v_and_b32 v9, 3, v253
    v_lshl_add_u32 v10, v9, 3, v10
    s_sub_u32 s81, s77, 1
    s_lshl_b32 s82, s81, 6
    v_add_u32 v10, s82, v10
    v_add_u32 v11, 49152, v10
    v_mov_b32 v4, 0x3f803f80
    v_mov_b32 v5, 0x3f803f80
    v_mov_b32 v6, 0x3f803f80
    v_mov_b32 v7, 0x3f803f80
    ds_read_b64_tr_b16 v[32:33], v10 offset:0
    ds_read_b64_tr_b16 v[34:35], v10 offset:1536
    ds_read_b64_tr_b16 v[36:37], v10 offset:3072
    ds_read_b64_tr_b16 v[38:39], v10 offset:4608
    ds_read_b64_tr_b16 v[40:41], v10 offset:6144
    ds_read_b64_tr_b16 v[42:43], v10 offset:7680
    ds_read_b64_tr_b16 v[44:45], v10 offset:9216
    ds_read_b64_tr_b16 v[46:47], v10 offset:10752
    ds_read_b64_tr_b16 v[48:49], v10 offset:12288
    ds_read_b64_tr_b16 v[50:51], v10 offset:13824
    ds_read_b64_tr_b16 v[52:53], v10 offset:15360
    ds_read_b64_tr_b16 v[54:55], v10 offset:16896
    ds_read_b64_tr_b16 v[56:57], v10 offset:18432
    ds_read_b64_tr_b16 v[58:59], v10 offset:19968
    s_waitcnt lgkmcnt(12)
    v_mfma_f32_32x32x16_bf16 v[16:31], v[32:35], v[4:7], 0
    ds_read_b64_tr_b16 v[60:61], v10 offset:21504
    ds_read_b64_tr_b16 v[62:63], v10 offset:23040
    s_waitcnt lgkmcnt(12)
    v_mfma_f32_32x32x16_bf16 v[16:31], v[36:39], v[4:7], v[16:31]
    ds_read_b64_tr_b16 v[32:33], v10 offset:24576
    ds_read_b64_tr_b16 v[34:35], v10 offset:26112
    s_waitcnt lgkmcnt(12)
    v_mfma_f32_32x32x16_bf16 v[16:31], v[40:43], v[4:7], v[16:31]
    ds_read_b64_tr_b16 v[36:37], v10 offset:27648
    ds_read_b64_tr_b16 v[38:39], v10 offset:29184
    s_waitcnt lgkmcnt(12)
    v_mfma_f32_32x32x16_bf16 v[16:31], v[44:47], v[4:7], v[16:31]
    ds_read_b64_tr_b16 v[40:41], v10 offset:30720
    ds_read_b64_tr_b16 v[42:43], v10 offset:32256
    s_waitcnt lgkmcnt(12)
    v_mfma_f32_32x32x16_bf16 v[16:31], v[48:51], v[4:7], v[16:31]
    ds_read_b64_tr_b16 v[44:45], v10 offset:33792
    ds_read_b64_tr_b16 v[46:47], v10 offset:35328
    s_waitcnt lgkmcnt(12)
    v_mfma_f32_32x32x16_bf16 v[16:31], v[52:55], v[4:7], v[16:31]
    ds_read_b64_tr_b16 v[48:49], v10 offset:36864
    ds_read_b64_tr_b16 v[50:51], v10 offset:38400
    s_waitcnt lgkmcnt(12)
    v_mfma_f32_32x32x16_bf16 v[16:31], v[56:59], v[4:7], v[16:31]
    ds_read_b64_tr_b16 v[52:53], v10 offset:39936
    ds_read_b64_tr_b16 v[54:55], v10 offset:41472
    s_waitcnt lgkmcnt(12)
    v_mfma_f32_32x32x16_bf16 v[16:31], v[60:63], v[4:7], v[16:31]
    ds_read_b64_tr_b16 v[56:57], v10 offset:43008
    ds_read_b64_tr_b16 v[58:59], v10 offset:44544
    s_waitcnt lgkmcnt(12)
    v_mfma_f32_32x32x16_bf16 v[16:31], v[32:35], v[4:7], v[16:31]
    ds_read_b64_tr_b16 v[60:61], v10 offset:46080
    ds_read_b64_tr_b16 v[62:63], v10 offset:47616
    s_waitcnt lgkmcnt(12)
    v_mfma_f32_32x32x16_bf16 v[16:31], v[36:39], v[4:7], v[16:31]
    ds_read_b64_tr_b16 v[32:33], v11 offset:0
    ds_read_b64_tr_b16 v[34:35], v11 offset:1536
    s_waitcnt lgkmcnt(12)
    v_mfma_f32_32x32x16_bf16 v[16:31], v[40:43], v[4:7], v[16:31]
    ds_read_b64_tr_b16 v[36:37], v11 offset:3072
    ds_read_b64_tr_b16 v[38:39], v11 offset:4608
    s_waitcnt lgkmcnt(12)
    v_mfma_f32_32x32x16_bf16 v[16:31], v[44:47], v[4:7], v[16:31]
    ds_read_b64_tr_b16 v[40:41], v11 offset:6144
    ds_read_b64_tr_b16 v[42:43], v11 offset:7680
    s_waitcnt lgkmcnt(12)
    v_mfma_f32_32x32x16_bf16 v[16:31], v[48:51], v[4:7], v[16:31]
    ds_read_b64_tr_b16 v[44:45], v11 offset:9216
    ds_read_b64_tr_b16 v[46:47], v11 offset:10752
    s_waitcnt lgkmcnt(12)
    v_mfma_f32_32x32x16_bf16 v[16:31], v[52:55], v[4:7], v[16:31]
    ds_read_b64_tr_b16 v[48:49], v11 offset:12288
    ds_read_b64_tr_b16 v[50:51], v11 offset:13824
    s_waitcnt lgkmcnt(12)
    v_mfma_f32_32x32x16_bf16 v[16:31], v[56:59], v[4:7], v[16:31]
    ds_read_b64_tr_b16 v[52:53], v11 offset:15360
    ds_read_b64_tr_b16 v[54:55], v11 offset:16896
    s_waitcnt lgkmcnt(12)
    v_mfma_f32_32x32x16_bf16 v[16:31], v[60:63], v[4:7], v[16:31]
    ds_read_b64_tr_b16 v[56:57], v11 offset:18432
    ds_read_b64_tr_b16 v[58:59], v11 offset:19968
    s_waitcnt lgkmcnt(12)
    v_mfma_f32_32x32x16_bf16 v[16:31], v[32:35], v[4:7], v[16:31]
    ds_read_b64_tr_b16 v[60:61], v11 offset:21504
    ds_read_b64_tr_b16 v[62:63], v11 offset:23040
    s_waitcnt lgkmcnt(12)
    v_mfma_f32_32x32x16_bf16 v[16:31], v[36:39], v[4:7], v[16:31]
    ds_read_b64_tr_b16 v[32:33], v11 offset:24576
    ds_read_b64_tr_b16 v[34:35], v11 offset:26112
    s_waitcnt lgkmcnt(12)
    v_mfma_f32_32x32x16_bf16 v[16:31], v[40:43], v[4:7], v[16:31]
    ds_read_b64_tr_b16 v[36:37], v11 offset:27648
    ds_read_b64_tr_b16 v[38:39], v11 offset:29184
    s_waitcnt lgkmcnt(12)
    v_mfma_f32_32x32x16_bf16 v[16:31], v[44:47], v[4:7], v[16:31]
    ds_read_b64_tr_b16 v[40:41], v11 offset:30720
    ds_read_b64_tr_b16 v[42:43], v11 offset:32256
    s_waitcnt lgkmcnt(12)
    v_mfma_f32_32x32x16_bf16 v[16:31], v[48:51], v[4:7], v[16:31]
    ds_read_b64_tr_b16 v[44:45], v11 offset:33792
    ds_read_b64_tr_b16 v[46:47], v11 offset:35328
    s_waitcnt lgkmcnt(12)
    v_mfma_f32_32x32x16_bf16 v[16:31], v[52:55], v[4:7], v[16:31]
    ds_read_b64_tr_b16 v[48:49], v11 offset:36864
    ds_read_b64_tr_b16 v[50:51], v11 offset:38400
    s_waitcnt lgkmcnt(12)
    v_mfma_f32_32x32x16_bf16 v[16:31], v[56:59], v[4:7], v[16:31]
    ds_read_b64_tr_b16 v[52:53], v11 offset:39936
    ds_read_b64_tr_b16 v[54:55], v11 offset:41472
    s_waitcnt lgkmcnt(12)
    v_mfma_f32_32x32x16_bf16 v[16:31], v[60:63], v[4:7], v[16:31]
    ds_read_b64_tr_b16 v[56:57], v11 offset:43008
    ds_read_b64_tr_b16 v[58:59], v11 offset:44544
    s_waitcnt lgkmcnt(12)
    v_mfma_f32_32x32x16_bf16 v[16:31], v[32:35], v[4:7], v[16:31]
    ds_read_b64_tr_b16 v[60:61], v11 offset:46080
    ds_read_b64_tr_b16 v[62:63], v11 offset:47616
    s_waitcnt lgkmcnt(12)
    v_mfma_f32_32x32x16_bf16 v[16:31], v[36:39], v[4:7], v[16:31]
    s_waitcnt lgkmcnt(10)
    v_mfma_f32_32x32x16_bf16 v[16:31], v[40:43], v[4:7], v[16:31]
    s_waitcnt lgkmcnt(8)
    v_mfma_f32_32x32x16_bf16 v[16:31], v[44:47], v[4:7], v[16:31]
    s_waitcnt lgkmcnt(6)
    v_mfma_f32_32x32x16_bf16 v[16:31], v[48:51], v[4:7], v[16:31]
    s_waitcnt lgkmcnt(4)
    v_mfma_f32_32x32x16_bf16 v[16:31], v[52:55], v[4:7], v[16:31]
    s_waitcnt lgkmcnt(2)
    v_mfma_f32_32x32x16_bf16 v[16:31], v[56:59], v[4:7], v[16:31]
    s_waitcnt lgkmcnt(0)
    v_mfma_f32_32x32x16_bf16 v[16:31], v[60:63], v[4:7], v[16:31]
    s_lshl_b32 s82, s81, 7
    s_add_u32 s82, s82, 147456
    v_lshrrev_b32 v9, 5, v253
    v_lshlrev_b32 v9, 4, v9
    v_add_u32 v9, s82, v9
    s_mov_b32 exec_lo, 1
    s_mov_b32 exec_hi, 1
    s_nop 7
    ds_write_b128 v9, v[16:19] offset:0
    ds_write_b128 v9, v[20:23] offset:32
    ds_write_b128 v9, v[24:27] offset:64
    ds_write_b128 v9, v[28:31] offset:96
    s_mov_b64 exec, -1
L3_h_j:
    s_waitcnt lgkmcnt(0)
    s_barrier
    s_lshl_b32 s81, s42, 3
    s_lshl_b32 s82, s100, 1
    s_add_u32 s81, s81, s82
    s_add_u32 s81, s81, s88
    s_lshl_b32 s82, s101, 1
    s_add_u32 s82, s82, s87
    s_lshl_b32 s83, s81, 5
    s_lshl_b32 s84, s82, 1
    s_add_u32 s83, s83, s84
    s_lshl_b32 s83, s83, 10
    s_add_u32 s83, s83, 7340032
    buffer_load_dwordx4 v[60:63], v252, s[12:15], s83 offen sc1
    buffer_load_dwordx4 v[64:67], v252, s[12:15], s83 offen offset:1024 sc1
    s_lshl_b32 s92, s81, 15
    s_lshl_b32 s82, s82, 6
    s_add_u32 s92, s92, s82
    s_lshl_b32 s81, s88, 14
    v_add_u32 v8, s81, v252
    v_add_u32 v9, 0x10000, v8
    v_add_u32 v10, 0x20000, v8
    s_barrier
    s_cmp_lg_u32 s77, 0
    s_cbranch_scc1 L3_g_np
    s_lshl_b32 s80, s42, 7
    s_add_u32 s80, s80, 69632
    s_lshl_b32 s81, s43, 2
    s_add_u32 s81, s81, s80
    v_mov_b32 v2, s45
    v_mov_b32 v3, 0
    s_mov_b64 exec, 1
    s_cmp_eq_u32 s46, 0
    s_cbranch_scc1 L_tf_g3_s
    buffer_store_dword v2, v3, s[12:15], s81 offen
    s_branch L_tf_g3_d
L_tf_g3_s:
    buffer_store_dword v2, v3, s[12:15], s81 offen sc1
L_tf_g3_d:
    s_mov_b64 exec, -1
    s_lshl_b32 s80, s42, 7
    s_add_u32 s80, s80, 69632
    s_lshl_b32 s81, s3, 6
    s_add_u32 s80, s80, s81
    v_and_b32 v2, 15, v253
    v_lshlrev_b32 v2, 2, v2
    s_mov_b32 s95, 0
L_poll_g3:
    buffer_load_dword v3, v2, s[12:15], s80 offen sc1
    s_add_u32 s95, s95, 1
    s_waitcnt vmcnt(0)
    v_cmp_ne_u32 vcc, s45, v3
    s_cmp_gt_u32 s95, 0x100000
    s_cbranch_scc1 L_poll_g3_x
    s_cbranch_vccnz L_poll_g3
L_poll_g3_x:
L3_g_np:
    s_waitcnt vmcnt(0)
    s_barrier
    s_barrier
    ds_read_b128 v[48:51], v8 offset:0
    ds_read_b128 v[52:55], v8 offset:1024
    ds_read_b128 v[56:59], v8 offset:2048
    ds_read_b128 v[4:7], v8 offset:3072
    ds_read_b128 v[12:15], v8 offset:4096
    ds_read_b128 v[68:71], v8 offset:5120
    s_waitcnt lgkmcnt(4)
    v_mfma_f32_32x32x16_bf16 v[16:31], v[80:83], v[48:51], 0
    v_mfma_f32_32x32x16_bf16 v[32:47], v[80:83], v[52:55], 0
    ds_read_b128 v[48:51], v8 offset:6144
    ds_read_b128 v[52:55], v8 offset:7168
    s_waitcnt lgkmcnt(4)
    v_mfma_f32_32x32x16_bf16 v[16:31], v[84:87], v[56:59], v[16:31]
    v_mfma_f32_32x32x16_bf16 v[32:47], v[84:87], v[4:7], v[32:47]
    ds_read_b128 v[56:59], v8 offset:8192
    ds_read_b128 v[4:7], v8 offset:9216
    s_waitcnt lgkmcnt(4)
    v_mfma_f32_32x32x16_bf16 v[16:31], v[88:91], v[12:15], v[16:31]
    v_mfma_f32_32x32x16_bf16 v[32:47], v[88:91], v[68:71], v[32:47]
    ds_read_b128 v[12:15], v8 offset:10240
    ds_read_b128 v[68:71], v8 offset:11264
    s_waitcnt lgkmcnt(4)
    v_mfma_f32_32x32x16_bf16 v[16:31], v[92:95], v[48:51], v[16:31]
    v_mfma_f32_32x32x16_bf16 v[32:47], v[92:95], v[52:55], v[32:47]
    ds_read_b128 v[48:51], v8 offset:12288
    ds_read_b128 v[52:55], v8 offset:13312
    s_waitcnt lgkmcnt(4)
    v_mfma_f32_32x32x16_bf16 v[16:31], v[96:99], v[56:59], v[16:31]
    v_mfma_f32_32x32x16_bf16 v[32:47], v[96:99], v[4:7], v[32:47]
    ds_read_b128 v[56:59], v8 offset:14336
    ds_read_b128 v[4:7], v8 offset:15360
    s_waitcnt lgkmcnt(4)
    v_mfma_f32_32x32x16_bf16 v[16:31], v[100:103], v[12:15], v[16:31]
    v_mfma_f32_32x32x16_bf16 v[32:47], v[100:103], v[68:71], v[32:47]
    s_waitcnt lgkmcnt(2)
    v_mfma_f32_32x32x16_bf16 v[16:31], v[104:107], v[48:51], v[16:31]
    v_mfma_f32_32x32x16_bf16 v[32:47], v[104:107], v[52:55], v[32:47]
    s_waitcnt lgkmcnt(0)
    v_mfma_f32_32x32x16_bf16 v[16:31], v[108:111], v[56:59], v[16:31]
    v_mfma_f32_32x32x16_bf16 v[32:47], v[108:111], v[4:7], v[32:47]
    s_barrier
    ds_read_b128 v[12:15], v8 offset:32768
    ds_read_b128 v[68:71], v8 offset:33792
    ds_read_b128 v[48:51], v8 offset:34816
    ds_read_b128 v[52:55], v8 offset:35840
    ds_read_b128 v[56:59], v8 offset:36864
    ds_read_b128 v[4:7], v8 offset:37888
    s_waitcnt lgkmcnt(4)
    v_mfma_f32_32x32x16_bf16 v[16:31], v[112:115], v[12:15], v[16:31]
    v_mfma_f32_32x32x16_bf16 v[32:47], v[112:115], v[68:71], v[32:47]
    ds_read_b128 v[12:15], v8 offset:38912
    ds_read_b128 v[68:71], v8 offset:39936
    s_waitcnt lgkmcnt(4)
    v_mfma_f32_32x32x16_bf16 v[16:31], v[116:119], v[48:51], v[16:31]
    v_mfma_f32_32x32x16_bf16 v[32:47], v[116:119], v[52:55], v[32:47]
    ds_read_b128 v[48:51], v8 offset:40960
    ds_read_b128 v[52:55], v8 offset:41984
    s_waitcnt lgkmcnt(4)
    v_mfma_f32_32x32x16_bf16 v[16:31], v[120:123], v[56:59], v[16:31]
    v_mfma_f32_32x32x16_bf16 v[32:47], v[120:123], v[4:7], v[32:47]
    ds_read_b128 v[56:59], v8 offset:43008
    ds_read_b128 v[4:7], v8 offset:44032
    s_waitcnt lgkmcnt(4)
    v_mfma_f32_32x32x16_bf16 v[16:31], v[124:127], v[12:15], v[16:31]
    v_mfma_f32_32x32x16_bf16 v[32:47], v[124:127], v[68:71], v[32:47]
    ds_read_b128 v[12:15], v8 offset:45056
    ds_read_b128 v[68:71], v8 offset:46080
    s_waitcnt lgkmcnt(4)
    v_mfma_f32_32x32x16_bf16 v[16:31], v[128:131], v[48:51], v[16:31]
    v_mfma_f32_32x32x16_bf16 v[32:47], v[128:131], v[52:55], v[32:47]
    ds_read_b128 v[48:51], v8 offset:47104
    ds_read_b128 v[52:55], v8 offset:48128
    s_waitcnt lgkmcnt(4)
    v_mfma_f32_32x32x16_bf16 v[16:31], v[132:135], v[56:59], v[16:31]
    v_mfma_f32_32x32x16_bf16 v[32:47], v[132:135], v[4:7], v[32:47]
    s_waitcnt lgkmcnt(2)
    v_mfma_f32_32x32x16_bf16 v[16:31], v[136:139], v[12:15], v[16:31]
    v_mfma_f32_32x32x16_bf16 v[32:47], v[136:139], v[68:71], v[32:47]
    s_waitcnt lgkmcnt(0)
    v_mfma_f32_32x32x16_bf16 v[16:31], v[140:143], v[48:51], v[16:31]
    v_mfma_f32_32x32x16_bf16 v[32:47], v[140:143], v[52:55], v[32:47]
    s_barrier
    ds_read_b128 v[56:59], v9 offset:0
    ds_read_b128 v[4:7], v9 offset:1024
    ds_read_b128 v[12:15], v9 offset:2048
    ds_read_b128 v[68:71], v9 offset:3072
    ds_read_b128 v[48:51], v9 offset:4096
    ds_read_b128 v[52:55], v9 offset:5120
    s_waitcnt lgkmcnt(4)
    v_mfma_f32_32x32x16_bf16 v[16:31], v[144:147], v[56:59], v[16:31]
    v_mfma_f32_32x32x16_bf16 v[32:47], v[144:147], v[4:7], v[32:47]
    ds_read_b128 v[56:59], v9 offset:6144
    ds_read_b128 v[4:7], v9 offset:7168
    s_waitcnt lgkmcnt(4)
    v_mfma_f32_32x32x16_bf16 v[16:31], v[148:151], v[12:15], v[16:31]
    v_mfma_f32_32x32x16_bf16 v[32:47], v[148:151], v[68:71], v[32:47]
    ds_read_b128 v[12:15], v9 offset:8192
    ds_read_b128 v[68:71], v9 offset:9216
    s_waitcnt lgkmcnt(4)
    v_mfma_f32_32x32x16_bf16 v[16:31], v[152:155], v[48:51], v[16:31]
    v_mfma_f32_32x32x16_bf16 v[32:47], v[152:155], v[52:55], v[32:47]
    ds_read_b128 v[48:51], v9 offset:10240
    ds_read_b128 v[52:55], v9 offset:11264
    s_waitcnt lgkmcnt(4)
    v_mfma_f32_32x32x16_bf16 v[16:31], v[156:159], v[56:59], v[16:31]
    v_mfma_f32_32x32x16_bf16 v[32:47], v[156:159], v[4:7], v[32:47]
    ds_read_b128 v[56:59], v9 offset:12288
    ds_read_b128 v[4:7], v9 offset:13312
    s_waitcnt lgkmcnt(4)
    v_mfma_f32_32x32x16_bf16 v[16:31], v[160:163], v[12:15], v[16:31]
    v_mfma_f32_32x32x16_bf16 v[32:47], v[160:163], v[68:71], v[32:47]
    ds_read_b128 v[12:15], v9 offset:14336
    ds_read_b128 v[68:71], v9 offset:15360
    s_waitcnt lgkmcnt(4)
    v_mfma_f32_32x32x16_bf16 v[16:31], v[164:167], v[48:51], v[16:31]
    v_mfma_f32_32x32x16_bf16 v[32:47], v[164:167], v[52:55], v[32:47]
    s_waitcnt lgkmcnt(2)
    v_mfma_f32_32x32x16_bf16 v[16:31], v[168:171], v[56:59], v[16:31]
    v_mfma_f32_32x32x16_bf16 v[32:47], v[168:171], v[4:7], v[32:47]
    s_waitcnt lgkmcnt(0)
    v_mfma_f32_32x32x16_bf16 v[16:31], v[172:175], v[12:15], v[16:31]
    v_mfma_f32_32x32x16_bf16 v[32:47], v[172:175], v[68:71], v[32:47]
    s_barrier
    ds_read_b128 v[48:51], v9 offset:32768
    ds_read_b128 v[52:55], v9 offset:33792
    ds_read_b128 v[56:59], v9 offset:34816
    ds_read_b128 v[4:7], v9 offset:35840
    ds_read_b128 v[12:15], v9 offset:36864
    ds_read_b128 v[68:71], v9 offset:37888
    s_waitcnt lgkmcnt(4)
    v_mfma_f32_32x32x16_bf16 v[16:31], v[176:179], v[48:51], v[16:31]
    v_mfma_f32_32x32x16_bf16 v[32:47], v[176:179], v[52:55], v[32:47]
    ds_read_b128 v[48:51], v9 offset:38912
    ds_read_b128 v[52:55], v9 offset:39936
    s_waitcnt lgkmcnt(4)
    v_mfma_f32_32x32x16_bf16 v[16:31], v[180:183], v[56:59], v[16:31]
    v_mfma_f32_32x32x16_bf16 v[32:47], v[180:183], v[4:7], v[32:47]
    ds_read_b128 v[56:59], v9 offset:40960
    ds_read_b128 v[4:7], v9 offset:41984
    s_waitcnt lgkmcnt(4)
    v_mfma_f32_32x32x16_bf16 v[16:31], v[184:187], v[12:15], v[16:31]
    v_mfma_f32_32x32x16_bf16 v[32:47], v[184:187], v[68:71], v[32:47]
    ds_read_b128 v[12:15], v9 offset:43008
    ds_read_b128 v[68:71], v9 offset:44032
    s_waitcnt lgkmcnt(4)
    v_mfma_f32_32x32x16_bf16 v[16:31], v[188:191], v[48:51], v[16:31]
    v_mfma_f32_32x32x16_bf16 v[32:47], v[188:191], v[52:55], v[32:47]
    ds_read_b128 v[48:51], v9 offset:45056
    ds_read_b128 v[52:55], v9 offset:46080
    s_waitcnt lgkmcnt(4)
    v_mfma_f32_32x32x16_bf16 v[16:31], v[192:195], v[56:59], v[16:31]
    v_mfma_f32_32x32x16_bf16 v[32:47], v[192:195], v[4:7], v[32:47]
    ds_read_b128 v[56:59], v9 offset:47104
    ds_read_b128 v[4:7], v9 offset:48128
    s_waitcnt lgkmcnt(4)
    v_mfma_f32_32x32x16_bf16 v[16:31], v[196:199], v[12:15], v[16:31]
    v_mfma_f32_32x32x16_bf16 v[32:47], v[196:199], v[68:71], v[32:47]
    s_waitcnt lgkmcnt(2)
    v_mfma_f32_32x32x16_bf16 v[16:31], v[200:203], v[48:51], v[16:31]
    v_mfma_f32_32x32x16_bf16 v[32:47], v[200:203], v[52:55], v[32:47]
    s_waitcnt lgkmcnt(0)
    v_mfma_f32_32x32x16_bf16 v[16:31], v[204:207], v[56:59], v[16:31]
    v_mfma_f32_32x32x16_bf16 v[32:47], v[204:207], v[4:7], v[32:47]
    s_barrier
    ds_read_b128 v[12:15], v10 offset:0
    ds_read_b128 v[68:71], v10 offset:1024
    ds_read_b128 v[48:51], v10 offset:2048
    ds_read_b128 v[52:55], v10 offset:3072
    ds_read_b128 v[56:59], v10 offset:4096
    ds_read_b128 v[4:7], v10 offset:5120
    s_waitcnt lgkmcnt(4)
    v_mfma_f32_32x32x16_bf16 v[16:31], v[208:211], v[12:15], v[16:31]
    v_mfma_f32_32x32x16_bf16 v[32:47], v[208:211], v[68:71], v[32:47]
    ds_read_b128 v[12:15], v10 offset:6144
    ds_read_b128 v[68:71], v10 offset:7168
    s_waitcnt lgkmcnt(4)
    v_mfma_f32_32x32x16_bf16 v[16:31], v[212:215], v[48:51], v[16:31]
    v_mfma_f32_32x32x16_bf16 v[32:47], v[212:215], v[52:55], v[32:47]
    ds_read_b128 v[48:51], v10 offset:8192
    ds_read_b128 v[52:55], v10 offset:9216
    s_waitcnt lgkmcnt(4)
    v_mfma_f32_32x32x16_bf16 v[16:31], v[216:219], v[56:59], v[16:31]
    v_mfma_f32_32x32x16_bf16 v[32:47], v[216:219], v[4:7], v[32:47]
    ds_read_b128 v[56:59], v10 offset:10240
    ds_read_b128 v[4:7], v10 offset:11264
    s_waitcnt lgkmcnt(4)
    v_mfma_f32_32x32x16_bf16 v[16:31], v[220:223], v[12:15], v[16:31]
    v_mfma_f32_32x32x16_bf16 v[32:47], v[220:223], v[68:71], v[32:47]
    ds_read_b128 v[12:15], v10 offset:12288
    ds_read_b128 v[68:71], v10 offset:13312
    s_waitcnt lgkmcnt(4)
    v_mfma_f32_32x32x16_bf16 v[16:31], v[224:227], v[48:51], v[16:31]
    v_mfma_f32_32x32x16_bf16 v[32:47], v[224:227], v[52:55], v[32:47]
    ds_read_b128 v[48:51], v10 offset:14336
    ds_read_b128 v[52:55], v10 offset:15360
    s_waitcnt lgkmcnt(4)
    v_mfma_f32_32x32x16_bf16 v[16:31], v[228:231], v[56:59], v[16:31]
    v_mfma_f32_32x32x16_bf16 v[32:47], v[228:231], v[4:7], v[32:47]
    s_waitcnt lgkmcnt(2)
    v_mfma_f32_32x32x16_bf16 v[16:31], v[232:235], v[12:15], v[16:31]
    v_mfma_f32_32x32x16_bf16 v[32:47], v[232:235], v[68:71], v[32:47]
    s_waitcnt lgkmcnt(0)
    v_mfma_f32_32x32x16_bf16 v[16:31], v[236:239], v[48:51], v[16:31]
    v_mfma_f32_32x32x16_bf16 v[32:47], v[236:239], v[52:55], v[32:47]
    s_barrier
    ds_read_b128 v[56:59], v8 offset:0
    ds_read_b128 v[4:7], v8 offset:1024
    ds_read_b128 v[12:15], v8 offset:2048
    ds_read_b128 v[68:71], v8 offset:3072
    ds_read_b128 v[48:51], v8 offset:4096
    ds_read_b128 v[52:55], v8 offset:5120
    s_waitcnt lgkmcnt(4)
    v_mfma_f32_32x32x16_bf16 v[16:31], v[240:243], v[56:59], v[16:31]
    v_mfma_f32_32x32x16_bf16 v[32:47], v[240:243], v[4:7], v[32:47]
    s_waitcnt lgkmcnt(2)
    v_mfma_f32_32x32x16_bf16 v[16:31], v[244:247], v[12:15], v[16:31]
    v_mfma_f32_32x32x16_bf16 v[32:47], v[244:247], v[68:71], v[32:47]
    s_waitcnt lgkmcnt(0)
    v_mfma_f32_32x32x16_bf16 v[16:31], v[248:251], v[48:51], v[16:31]
    v_mfma_f32_32x32x16_bf16 v[32:47], v[248:251], v[52:55], v[32:47]
    s_lshl_b32 s81, s77, 12
    v_add_u32 v8, s81, v252
    s_xor_b32 s81, s81, 4096
    v_add_u32 v9, s81, v252
    s_nop 4
    s_barrier
    s_cmp_eq_u32 s88, 0
    s_cbranch_scc0 L3_f_k1
    ds_write_b128 v8, v[32:35] offset:0
    ds_write_b128 v8, v[36:39] offset:1024
    ds_write_b128 v8, v[40:43] offset:2048
    ds_write_b128 v8, v[44:47] offset:3072
    v_lshlrev_b32 v128, 16, v72
    v_and_b32 v129, 0xffff0000, v72
    v_lshlrev_b32 v130, 16, v73
    v_and_b32 v131, 0xffff0000, v73
    v_lshlrev_b32 v132, 16, v74
    v_and_b32 v133, 0xffff0000, v74
    v_lshlrev_b32 v134, 16, v75
    v_and_b32 v135, 0xffff0000, v75
    v_lshlrev_b32 v136, 16, v76
    v_and_b32 v137, 0xffff0000, v76
    v_lshlrev_b32 v138, 16, v77
    v_and_b32 v139, 0xffff0000, v77
    v_lshlrev_b32 v140, 16, v78
    v_and_b32 v141, 0xffff0000, v78
    v_lshlrev_b32 v142, 16, v79
    v_and_b32 v143, 0xffff0000, v79
    v_pk_add_f32 v[80:81], v[16:17], v[128:129]
    v_pk_add_f32 v[82:83], v[18:19], v[130:131]
    v_pk_add_f32 v[84:85], v[20:21], v[132:133]
    v_pk_add_f32 v[86:87], v[22:23], v[134:135]
    v_pk_add_f32 v[88:89], v[24:25], v[136:137]
    v_pk_add_f32 v[90:91], v[26:27], v[138:139]
    v_pk_add_f32 v[92:93], v[28:29], v[140:141]
    v_pk_add_f32 v[94:95], v[30:31], v[142:143]
    v_lshlrev_b32 v128, 16, v60
    v_and_b32 v129, 0xffff0000, v60
    v_lshlrev_b32 v130, 16, v61
    v_and_b32 v131, 0xffff0000, v61
    v_lshlrev_b32 v132, 16, v62
    v_and_b32 v133, 0xffff0000, v62
    v_lshlrev_b32 v134, 16, v63
    v_and_b32 v135, 0xffff0000, v63
    v_lshlrev_b32 v136, 16, v64
    v_and_b32 v137, 0xffff0000, v64
    v_lshlrev_b32 v138, 16, v65
    v_and_b32 v139, 0xffff0000, v65
    v_lshlrev_b32 v140, 16, v66
    v_and_b32 v141, 0xffff0000, v66
    v_lshlrev_b32 v142, 16, v67
    v_and_b32 v143, 0xffff0000, v67
    v_pk_add_f32 v[80:81], v[80:81], v[128:129]
    v_pk_add_f32 v[82:83], v[82:83], v[130:131]
    v_pk_add_f32 v[84:85], v[84:85], v[132:133]
    v_pk_add_f32 v[86:87], v[86:87], v[134:135]
    v_pk_add_f32 v[88:89], v[88:89], v[136:137]
    v_pk_add_f32 v[90:91], v[90:91], v[138:139]
    v_pk_add_f32 v[92:93], v[92:93], v[140:141]
    v_pk_add_f32 v[94:95], v[94:95], v[142:143]
    s_branch L3_f_j
L3_f_k1:
    ds_write_b128 v8, v[16:19] offset:0
    ds_write_b128 v8, v[20:23] offset:1024
    ds_write_b128 v8, v[24:27] offset:2048
    ds_write_b128 v8, v[28:31] offset:3072
    v_lshlrev_b32 v128, 16, v72
    v_and_b32 v129, 0xffff0000, v72
    v_lshlrev_b32 v130, 16, v73
    v_and_b32 v131, 0xffff0000, v73
    v_lshlrev_b32 v132, 16, v74
    v_and_b32 v133, 0xffff0000, v74
    v_lshlrev_b32 v134, 16, v75
    v_and_b32 v135, 0xffff0000, v75
    v_lshlrev_b32 v136, 16, v76
    v_and_b32 v137, 0xffff0000, v76
    v_lshlrev_b32 v138, 16, v77
    v_and_b32 v139, 0xffff0000, v77
    v_lshlrev_b32 v140, 16, v78
    v_and_b32 v141, 0xffff0000, v78
    v_lshlrev_b32 v142, 16, v79
    v_and_b32 v143, 0xffff0000, v79
    v_pk_add_f32 v[80:81], v[32:33], v[128:129]
    v_pk_add_f32 v[82:83], v[34:35], v[130:131]
    v_pk_add_f32 v[84:85], v[36:37], v[132:133]
    v_pk_add_f32 v[86:87], v[38:39], v[134:135]
    v_pk_add_f32 v[88:89], v[40:41], v[136:137]
    v_pk_add_f32 v[90:91], v[42:43], v[138:139]
    v_pk_add_f32 v[92:93], v[44:45], v[140:141]
    v_pk_add_f32 v[94:95], v[46:47], v[142:143]
    v_lshlrev_b32 v128, 16, v60
    v_and_b32 v129, 0xffff0000, v60
    v_lshlrev_b32 v130, 16, v61
    v_and_b32 v131, 0xffff0000, v61
    v_lshlrev_b32 v132, 16, v62
    v_and_b32 v133, 0xffff0000, v62
    v_lshlrev_b32 v134, 16, v63
    v_and_b32 v135, 0xffff0000, v63
    v_lshlrev_b32 v136, 16, v64
    v_and_b32 v137, 0xffff0000, v64
    v_lshlrev_b32 v138, 16, v65
    v_and_b32 v139, 0xffff0000, v65
    v_lshlrev_b32 v140, 16, v66
    v_and_b32 v141, 0xffff0000, v66
    v_lshlrev_b32 v142, 16, v67
    v_and_b32 v143, 0xffff0000, v67
    v_pk_add_f32 v[80:81], v[80:81], v[128:129]
    v_pk_add_f32 v[82:83], v[82:83], v[130:131]
    v_pk_add_f32 v[84:85], v[84:85], v[132:133]
    v_pk_add_f32 v[86:87], v[86:87], v[134:135]
    v_pk_add_f32 v[88:89], v[88:89], v[136:137]
    v_pk_add_f32 v[90:91], v[90:91], v[138:139]
    v_pk_add_f32 v[92:93], v[92:93], v[140:141]
    v_pk_add_f32 v[94:95], v[94:95], v[142:143]
L3_f_j:
    s_waitcnt lgkmcnt(0)
    s_barrier
    ds_read_b128 v[96:99], v9 offset:0
    ds_read_b128 v[100:103], v9 offset:1024
    ds_read_b128 v[104:107], v9 offset:2048
    ds_read_b128 v[108:111], v9 offset:3072
    v_and_b32 v8, 31, v253
    v_lshlrev_b32 v8, 10, v8
    v_lshrrev_b32 v9, 5, v253
    v_lshl_add_u32 v8, v9, 4, v8
    s_waitcnt lgkmcnt(0)
    v_pk_add_f32 v[80:81], v[80:81], v[96:97]
    v_pk_add_f32 v[82:83], v[82:83], v[98:99]
    v_pk_add_f32 v[84:85], v[84:85], v[100:101]
    v_pk_add_f32 v[86:87], v[86:87], v[102:103]
    v_pk_add_f32 v[88:89], v[88:89], v[104:105]
    v_pk_add_f32 v[90:91], v[90:91], v[106:107]
    v_pk_add_f32 v[92:93], v[92:93], v[108:109]
    v_pk_add_f32 v[94:95], v[94:95], v[110:111]
    v_cvt_pk_bf16_f32 v112, v80, v81
    v_cvt_pk_bf16_f32 v113, v82, v83
    v_cvt_pk_bf16_f32 v114, v84, v85
    v_cvt_pk_bf16_f32 v115, v86, v87
    v_cvt_pk_bf16_f32 v116, v88, v89
    v_cvt_pk_bf16_f32 v117, v90, v91
    v_cvt_pk_bf16_f32 v118, v92, v93
    v_cvt_pk_bf16_f32 v119, v94, v95
    s_nop 1
    v_permlane32_swap_b32 v112, v114
    v_permlane32_swap_b32 v113, v115
    v_permlane32_swap_b32 v116, v118
    v_permlane32_swap_b32 v117, v119
    s_nop 0
    buffer_store_dwordx4 v[112:115], v8, s[28:31], s92 offen
    buffer_store_dwordx4 v[116:119], v8, s[28:31], s92 offen offset:32
L3_done:
    s_or_b32 s80, s2, s44
    s_cmp_lg_u32 s80, 0
    s_cbranch_scc1 L_fin
    s_mov_b32 s80, 0
    v_mov_b32 v2, s45
    v_mov_b32 v3, 0
    s_mov_b64 exec, 1
    buffer_store_dword v2, v3, s[12:15], s80 offen sc1
    s_mov_b64 exec, -1
L_fin:
    s_waitcnt vmcnt(0)
L_end:
    s_endpgm
.section .rodata,"a"
.p2align 6
.amdhsa_kernel sequential_preLN__mha_block__dense_activation_squared_relu__prompt_kernel
  .amdhsa_next_free_vgpr 256
  .amdhsa_next_free_sgpr 102
  .amdhsa_accum_offset 256
  .amdhsa_group_segment_fixed_size 0
  .amdhsa_kernarg_size 88
  .amdhsa_user_sgpr_count 2
  .amdhsa_user_sgpr_kernarg_segment_ptr 1
  .amdhsa_system_sgpr_workgroup_id_x 1
.end_amdhsa_kernel
```
